```python
import torch

def _softmax(x, axis=-1):
    return torch.softmax(x, dim=axis)
def _gelu(x):
    return torch.nn.functional.gelu(x, approximate="tanh")
def _silu(x):
    return torch.nn.functional.silu(x)
def _sigmoid(x):
    return torch.sigmoid(x)
def _layernorm(x, axis=-1, eps=1e-5):
    m = x.mean(dim=axis, keepdim=True)
    v = x.var(dim=axis, keepdim=True, unbiased=False)
    return (x - m) / torch.sqrt(v + eps)
def _scatter_add(tgt, idx, src, axis=0):
    return tgt.clone().index_add_(axis, idx, src)
def _segment_sum(src, seg, n):
    out = torch.zeros((n,) + src.shape[1:], dtype=src.dtype)
    return out.index_add_(0, seg, src)
def _pad(x, pw):
    flat = tuple(v for pair in reversed(pw) for v in pair)
    return torch.nn.functional.pad(x, flat)

kernel_name = 'interleave_layers__spectral_fnet__moe_arch_mod__prompt'

def setup_inputs():

    _w = (lambda a: (lambda t: t.to(torch.bfloat16) if t.is_floating_point() else t)(torch.as_tensor(a)))
    def _A_setup():
        B, S, D = 1, 2048, 512
        ns = torch.arange(S)[:, None] * torch.arange(S)[None, :]
        nd = torch.arange(D)[:, None] * torch.arange(D)[None, :]
        Ws_re = torch.cos(-2.0 * torch.pi * ns / S).to(float)
        Ws_im = torch.sin(-2.0 * torch.pi * ns / S).to(float)
        Wd_re = torch.cos(-2.0 * torch.pi * nd / D).to(float)
        Wd_im = torch.sin(-2.0 * torch.pi * nd / D).to(float)
        return {
            "x": _w((lambda *s: torch.randn(*s, dtype=torch.bfloat16) * 0.05)(B, S, D)),
            "dft_seq_re": _w(Ws_re),
            "dft_seq_im": _w(Ws_im),
            "dft_hid_re": _w(Wd_re),
            "dft_hid_im": _w(Wd_im),
        }
    _A_in = _A_setup()

    def _B_setup():
        B, S, D, F, C = 1, 2048, 512, 1376, 1
        return {
            "x": _w((lambda *s: torch.randn(*s, dtype=torch.bfloat16) * 0.05)(B, S, D)),
            "w_r": _w((lambda *s: torch.randn(*s, dtype=torch.bfloat16) * 1.6)(D)),
            "w_gate": _w((lambda *s: torch.randn(*s, dtype=torch.bfloat16) * 0.4)(D, F)),
            "w_up": _w((lambda *s: torch.randn(*s, dtype=torch.bfloat16) * 0.4)(D, F)),
            "w_down": _w((lambda *s: torch.randn(*s, dtype=torch.bfloat16) * 0.4)(F, D)),
        }
    _B_in = _B_setup()

    return {
        "A_x": _A_in["x"],
        "A_dft_seq_re": _A_in["dft_seq_re"],
        "A_dft_seq_im": _A_in["dft_seq_im"],
        "A_dft_hid_re": _A_in["dft_hid_re"],
        "A_dft_hid_im": _A_in["dft_hid_im"],
        "B_x": _B_in["x"],
        "B_w_r": _B_in["w_r"],
        "B_w_gate": _B_in["w_gate"],
        "B_w_up": _B_in["w_up"],
        "B_w_down": _B_in["w_down"],
    }

def reference(A_x, A_dft_seq_re, A_dft_seq_im, A_dft_hid_re, A_dft_hid_im, B_x, B_w_r, B_w_gate, B_w_up, B_w_down):
    def _A_ref(x, dft_seq_re, dft_seq_im, dft_hid_re, dft_hid_im):
        a = torch.einsum("bsd,ed->bse", x, dft_hid_re)
        b = torch.einsum("bsd,ed->bse", x, dft_hid_im)
        y = torch.einsum("ts,bse->bte", dft_seq_re, a) - torch.einsum("ts,bse->bte", dft_seq_im, b)
        return y

    def _B_ref(x, w_r, w_gate, w_up, w_down):
        B, S, D = x.shape
        C = 1
        r = x @ w_r
        idx = torch.argsort(-r, axis=-1)[:, :C]
        idx_e = (lambda x, n, axis: torch.repeat_interleave(x, n, dim=axis))(idx.reshape(B, C, 1), D, axis=2)
        x_sel = (lambda x, i, axis: torch.take_along_dim(x, i, dim=axis))(x, idx_e, axis=1)
        g = _silu(x_sel @ w_gate)
        u = x_sel @ w_up
        y = (g * u) @ w_down
        r_sel = _sigmoid((lambda x, i, axis: torch.take_along_dim(x, i, dim=axis))(r, idx, axis=1))
        y = y * r_sel.reshape(B, C, 1)
        b_off = (torch.arange(B) * S).reshape(B, 1)
        flat_idx = (idx + b_off).reshape(B * C)
        zero = (x * 0.0).reshape(B * S, D)
        upd = _scatter_add(zero, flat_idx, y.reshape(B * C, D), axis=0)
        return x + upd.reshape(B, S, D)

    x = A_x
    x = x + _A_ref(_layernorm(x, axis=-1), A_dft_seq_re, A_dft_seq_im, A_dft_hid_re, A_dft_hid_im)
    x = x + _B_ref(_layernorm(x, axis=-1), B_w_r, B_w_gate, B_w_up, B_w_down)
    x = x + _A_ref(_layernorm(x, axis=-1), A_dft_seq_re, A_dft_seq_im, A_dft_hid_re, A_dft_hid_im)
    x = x + _B_ref(_layernorm(x, axis=-1), B_w_r, B_w_gate, B_w_up, B_w_down)
    return x
```

```asm
; @launch grid=(247,1,1) block=(512,1,1) lds=53248
.amdgcn_target "amdgcn-amd-amdhsa--gfx950"
.text
.globl interleave_layers__spectral_fnet__moe_arch_mod__prompt_kernel
.p2align 8
.type interleave_layers__spectral_fnet__moe_arch_mod__prompt_kernel,@function
interleave_layers__spectral_fnet__moe_arch_mod__prompt_kernel:
    s_cmp_ge_u32 s2, 247
    s_cbranch_scc1 L_end
    s_load_dwordx2 s[4:5], s[0:1], 0
    s_load_dwordx4 s[64:67], s[0:1], 80
    s_load_dwordx2 s[68:69], s[0:1], 96
    s_load_dwordx4 s[56:59], s[0:1], 48
    s_load_dwordx4 s[60:63], s[0:1], 64
    v_lshrrev_b32 v76, 6, v0
    v_and_b32 v1, 63, v0
    v_readfirstlane_b32 s40, v76
    v_and_b32_e64 v2, 15, v0
    v_bfe_u32 v3, v0, 4, 2
    s_lshl_b32 s43, s40, 8
    s_add_u32 s41, s43, s2
    s_and_b32 s41, s41, 2047
    s_sub_u32 s42, 2048, s41
    s_and_b32 s42, s42, 2047
    v_lshlrev_b32 v109, 4, v1
    s_lshl_b32 s44, s41, 10
    s_lshl_b32 s45, s42, 10
    v_add_u32 v110, s44, v109
    v_add_u32 v111, s45, v109
    s_waitcnt lgkmcnt(0)
    s_cmp_gt_u32 s2, 128
    s_cbranch_scc1 L_nox_1
    global_load_dwordx4 v[112:115], v110, s[4:5]
    global_load_dwordx4 v[116:119], v111, s[4:5]
L_nox_1:
    s_mov_b32 s12, s68
    s_and_b32 s13, s69, 0xffff
    s_mov_b32 s14, 5480448
    s_mov_b32 s15, 0x00020000
    s_mov_b32 s20, s66
    s_and_b32 s21, s67, 0xffff
    s_mov_b32 s22, 256
    s_mov_b32 s23, 0x00020000
    s_mov_b32 s16, s64
    s_and_b32 s17, s65, 0xffff
    s_mov_b32 s18, 2097152
    s_mov_b32 s19, 0x00020000
    s_mov_b32 s24, s56
    s_and_b32 s25, s57, 0xffff
    s_mov_b32 s26, 1024
    s_mov_b32 s27, 0x00020000
    s_mov_b32 s28, s58
    s_and_b32 s29, s59, 0xffff
    s_mov_b32 s30, 1409024
    s_mov_b32 s31, 0x00020000
    s_mov_b32 s32, s60
    s_and_b32 s33, s61, 0xffff
    s_mov_b32 s34, 1409024
    s_mov_b32 s35, 0x00020000
    s_mov_b32 s36, s62
    s_and_b32 s37, s63, 0xffff
    s_mov_b32 s38, 1409024
    s_mov_b32 s39, 0x00020000
    s_cmp_gt_u32 s2, 128
    s_cbranch_scc1 L_ffn
    v_cvt_f32_u32_e64 v76, v2
    v_cvt_f32_u32 v77, v3
    v_lshlrev_b32 v96, 4, v1
    s_cmp_lg_u32 s40, 0
    s_cbranch_scc1 L_gw_3
    v_add_f32 v78, 0x00000000, v76
    v_mul_f32 v78, 0x3d000000, v78
    v_mul_f32 v79, 0x41000000, v77
    v_mul_f32 v79, v79, v78
    v_cos_f32 v80, v79
    v_add_f32 v79, v79, v78
    v_cos_f32 v81, v79
    v_add_f32 v79, v79, v78
    v_cos_f32 v82, v79
    v_add_f32 v79, v79, v78
    v_cos_f32 v83, v79
    v_add_f32 v79, v79, v78
    v_cos_f32 v84, v79
    v_add_f32 v79, v79, v78
    v_cos_f32 v85, v79
    v_add_f32 v79, v79, v78
    v_cos_f32 v86, v79
    v_add_f32 v79, v79, v78
    v_cos_f32 v87, v79
    v_cvt_pk_f16_f32 v92, v80, v81
    v_cvt_pk_f16_f32 v93, v82, v83
    v_cvt_pk_f16_f32 v94, v84, v85
    v_cvt_pk_f16_f32 v95, v86, v87
    ds_write_b128 v96, v[92:95] offset:36864
    v_add_f32 v78, 0x00000000, v76
    v_mul_f32 v78, 0x3b000000, v78
    v_mul_f32 v79, 4.0, v77
    v_mul_f32 v79, v79, v78
    v_cos_f32 v92, v79
    v_add_f32 v79, v79, v78
    v_cos_f32 v93, v79
    v_add_f32 v79, v79, v78
    v_cos_f32 v94, v79
    v_add_f32 v79, v79, v78
    v_cos_f32 v95, v79
    s_nop 0
    ds_write_b128 v96, v[92:95] offset:40960
    s_branch L_gjoin_2
L_gw_3:
    s_cmp_lg_u32 s40, 1
    s_cbranch_scc1 L_gw_4
    v_add_f32_e64 v78, 0x00000000, v76
    v_mul_f32 v78, 0x3d000000, v78
    v_mul_f32 v79, 0x41000000, v77
    v_mul_f32 v79, v79, v78
    v_add_f32 v79, 0x3e800000, v79
    v_cos_f32 v80, v79
    v_add_f32 v79, v79, v78
    v_cos_f32 v81, v79
    v_add_f32 v79, v79, v78
    v_cos_f32 v82, v79
    v_add_f32 v79, v79, v78
    v_cos_f32 v83, v79
    v_add_f32 v79, v79, v78
    v_cos_f32 v84, v79
    v_add_f32 v79, v79, v78
    v_cos_f32 v85, v79
    v_add_f32 v79, v79, v78
    v_cos_f32 v86, v79
    v_add_f32 v79, v79, v78
    v_cos_f32 v87, v79
    v_cvt_pk_f16_f32 v92, v80, v81
    v_cvt_pk_f16_f32 v93, v82, v83
    v_cvt_pk_f16_f32 v94, v84, v85
    v_cvt_pk_f16_f32 v95, v86, v87
    ds_write_b128 v96, v[92:95] offset:37888
    v_add_f32 v78, 0x00000000, v76
    v_mul_f32 v78, 0x3b000000, v78
    v_mul_f32 v79, 4.0, v77
    v_mul_f32 v79, v79, v78
    v_add_f32 v79, 0xbe800000, v79
    v_cos_f32 v92, v79
    v_add_f32 v79, v79, v78
    v_cos_f32 v93, v79
    v_add_f32 v79, v79, v78
    v_cos_f32 v94, v79
    v_add_f32 v79, v79, v78
    v_cos_f32 v95, v79
    s_nop 0
    ds_write_b128 v96, v[92:95] offset:41984
    s_branch L_gjoin_2
L_gw_4:
    s_cmp_lg_u32 s40, 2
    s_cbranch_scc1 L_gw_5
    v_add_f32 v78, 0x41800000, v76
    v_mul_f32 v78, 0x3d000000, v78
    v_mul_f32 v79, 0x41000000, v77
    v_mul_f32 v79, v79, v78
    v_cos_f32 v80, v79
    v_add_f32 v79, v79, v78
    v_cos_f32 v81, v79
    v_add_f32 v79, v79, v78
    v_cos_f32 v82, v79
    v_add_f32 v79, v79, v78
    v_cos_f32 v83, v79
    v_add_f32 v79, v79, v78
    v_cos_f32 v84, v79
    v_add_f32 v79, v79, v78
    v_cos_f32 v85, v79
    v_add_f32 v79, v79, v78
    v_cos_f32 v86, v79
    v_add_f32 v79, v79, v78
    v_cos_f32 v87, v79
    v_cvt_pk_f16_f32 v92, v80, v81
    v_cvt_pk_f16_f32 v93, v82, v83
    v_cvt_pk_f16_f32 v94, v84, v85
    v_cvt_pk_f16_f32 v95, v86, v87
    ds_write_b128 v96, v[92:95] offset:38912
    v_add_f32 v78, 0x41800000, v76
    v_mul_f32 v78, 0x3b000000, v78
    v_mul_f32_e64 v79, 4.0, v77
    v_mul_f32 v79, v79, v78
    v_cos_f32 v92, v79
    v_add_f32 v79, v79, v78
    v_cos_f32 v93, v79
    v_add_f32 v79, v79, v78
    v_cos_f32 v94, v79
    v_add_f32 v79, v79, v78
    v_cos_f32 v95, v79
    s_nop 0
    ds_write_b128 v96, v[92:95] offset:43008
    s_branch L_gjoin_2
L_gw_5:
    s_cmp_lg_u32 s40, 3
    s_cbranch_scc1 L_gw_6
    v_add_f32 v78, 0x41800000, v76
    v_mul_f32 v78, 0x3d000000, v78
    v_mul_f32 v79, 0x41000000, v77
    v_mul_f32 v79, v79, v78
    v_add_f32 v79, 0x3e800000, v79
    v_cos_f32 v80, v79
    v_add_f32 v79, v79, v78
    v_cos_f32 v81, v79
    v_add_f32 v79, v79, v78
    v_cos_f32 v82, v79
    v_add_f32 v79, v79, v78
    v_cos_f32 v83, v79
    v_add_f32 v79, v79, v78
    v_cos_f32 v84, v79
    v_add_f32 v79, v79, v78
    v_cos_f32 v85, v79
    v_add_f32 v79, v79, v78
    v_cos_f32 v86, v79
    v_add_f32 v79, v79, v78
    v_cos_f32 v87, v79
    v_cvt_pk_f16_f32 v92, v80, v81
    v_cvt_pk_f16_f32 v93, v82, v83
    v_cvt_pk_f16_f32 v94, v84, v85
    v_cvt_pk_f16_f32 v95, v86, v87
    ds_write_b128 v96, v[92:95] offset:39936
    v_add_f32 v78, 0x41800000, v76
    v_mul_f32 v78, 0x3b000000, v78
    v_mul_f32 v79, 4.0, v77
    v_mul_f32 v79, v79, v78
    v_add_f32 v79, 0xbe800000, v79
    v_cos_f32 v92, v79
    v_add_f32 v79, v79, v78
    v_cos_f32 v93, v79
    v_add_f32 v79, v79, v78
    v_cos_f32 v94, v79
    v_add_f32 v79, v79, v78
    v_cos_f32 v95, v79
    s_nop 0
    ds_write_b128 v96, v[92:95] offset:44032
    s_branch L_gjoin_2
L_gw_6:
    s_cmp_lg_u32 s40, 4
    s_cbranch_scc1 L_gw_7
    v_lshrrev_b32 v97, 1, v2
    v_cvt_f32_u32 v78, v97
    v_mul_f32 v78, 0x3d800000, v78
    v_and_b32 v97, 1, v2
    v_cvt_f32_u32 v98, v97
    v_mul_f32 v98, 0x3e800000, v98
    v_mul_f32 v79, 4.0, v77
    v_mul_f32 v79, v79, v78
    v_add_f32 v79, v79, v98
    v_add_f32 v99, 0xbe800000, v79
    v_cos_f32 v80, v79
    v_cos_f32 v81, v99
    v_add_f32 v79, v79, v78
    v_add_f32 v99, 0xbe800000, v79
    v_cos_f32 v82, v79
    v_cos_f32 v83, v99
    v_add_f32 v79, v79, v78
    v_add_f32 v99, 0xbe800000, v79
    v_cos_f32 v84, v79
    v_cos_f32 v85, v99
    v_add_f32 v79, v79, v78
    v_add_f32 v99, 0xbe800000, v79
    v_cos_f32 v86, v79
    v_cos_f32_e64 v87, v99
    v_cvt_pk_f16_f32 v92, v80, v81
    v_cvt_pk_f16_f32 v93, v82, v83
    v_cvt_pk_f16_f32 v94, v84, v85
    v_cvt_pk_f16_f32 v95, v86, v87
    ds_write_b128 v96, v[92:95] offset:45056
    v_add_f32_e64 v78, 0x00000000, v76
    v_mul_f32 v78, 0x3b800000, v78
    v_mul_f32 v79, 4.0, v77
    v_mul_f32 v79, v79, v78
    v_cos_f32 v92, v79
    v_add_f32 v79, v79, v78
    v_cos_f32 v93, v79
    v_add_f32 v79, v79, v78
    v_cos_f32 v94, v79
    v_add_f32 v79, v79, v78
    v_cos_f32 v95, v79
    s_nop 0
    ds_write_b128 v96, v[92:95] offset:2048
    s_branch L_gjoin_2
L_gw_7:
    s_cmp_lg_u32 s40, 5
    s_cbranch_scc1 L_gw_8
    v_lshrrev_b32 v97, 2, v2
    v_add_u32 v97, 0, v97
    v_cvt_f32_u32 v78, v97
    v_cvt_f32_u32 v79, s2
    v_mul_f32 v79, v79, v78
    v_mul_f32 v79, 0x3a000000, v79
    v_mul_f32 v78, 0x3e000000, v78
    v_and_b32 v97, 3, v2
    v_lshl_add_u32 v97, v97, 2, v3
    v_lshlrev_b32 v97, 1, v97
    v_mov_b32 v98, 0xe334c1bc
    v_lshrrev_b32 v98, v97, v98
    v_and_b32 v98, 3, v98
    v_cvt_f32_u32 v98, v98
    v_fmac_f32 v79, 0x3e800000, v98
    v_cos_f32 v80, v79
    v_add_f32 v79, v79, v78
    v_cos_f32 v81, v79
    v_add_f32 v79, v79, v78
    v_cos_f32 v82, v79
    v_add_f32 v79, v79, v78
    v_cos_f32 v83, v79
    v_add_f32 v79, v79, v78
    v_cos_f32 v84, v79
    v_add_f32 v79, v79, v78
    v_cos_f32 v85, v79
    v_add_f32 v79, v79, v78
    v_cos_f32 v86, v79
    v_add_f32 v79, v79, v78
    v_cos_f32 v87, v79
    v_mul_f32 v80, 0x3e800000, v80
    v_mul_f32 v81, 0x3e800000, v81
    v_mul_f32 v82, 0x3e800000, v82
    v_mul_f32 v83, 0x3e800000, v83
    v_mul_f32 v84, 0x3e800000, v84
    v_mul_f32 v85, 0x3e800000, v85
    v_mul_f32 v86, 0x3e800000, v86
    v_mul_f32 v87, 0x3e800000, v87
    v_cvt_pk_f16_f32 v92, v80, v81
    v_cvt_pk_f16_f32 v93, v82, v83
    v_cvt_pk_f16_f32 v94, v84, v85
    v_cvt_pk_f16_f32 v95, v86, v87
    ds_write_b128 v96, v[92:95] offset:46080
    v_add_f32 v78, 0x00000000, v76
    v_mul_f32 v78, 0x3b800000, v78
    v_mul_f32 v79, 4.0, v77
    v_mul_f32 v79, v79, v78
    v_add_f32 v79, 0xbe800000, v79
    v_cos_f32 v92, v79
    v_add_f32 v79, v79, v78
    v_cos_f32 v93, v79
    v_add_f32 v79, v79, v78
    v_cos_f32 v94, v79
    v_add_f32 v79, v79, v78
    v_cos_f32 v95, v79
    s_nop 0
    ds_write_b128 v96, v[92:95] offset:3072
    s_branch L_gjoin_2
L_gw_8:
    s_cmp_lg_u32 s40, 6
    s_cbranch_scc1 L_gw_9
    v_lshrrev_b32 v97, 2, v2
    v_add_u32 v97, 4, v97
    v_cvt_f32_u32 v78, v97
    v_cvt_f32_u32 v79, s2
    v_mul_f32_e64 v79, v79, v78
    v_mul_f32 v79, 0x3a000000, v79
    v_mul_f32 v78, 0x3e000000, v78
    v_and_b32 v97, 3, v2
    v_lshl_add_u32 v97, v97, 2, v3
    v_lshlrev_b32 v97, 1, v97
    v_mov_b32 v98, 0xe334c1bc
    v_lshrrev_b32 v98, v97, v98
    v_and_b32 v98, 3, v98
    v_cvt_f32_u32 v98, v98
    v_fmac_f32 v79, 0x3e800000, v98
    v_cos_f32 v80, v79
    v_add_f32 v79, v79, v78
    v_cos_f32 v81, v79
    v_add_f32 v79, v79, v78
    v_cos_f32 v82, v79
    v_add_f32 v79, v79, v78
    v_cos_f32 v83, v79
    v_add_f32 v79, v79, v78
    v_cos_f32 v84, v79
    v_add_f32 v79, v79, v78
    v_cos_f32 v85, v79
    v_add_f32 v79, v79, v78
    v_cos_f32 v86, v79
    v_add_f32 v79, v79, v78
    v_cos_f32 v87, v79
    v_mul_f32 v80, 0x3e800000, v80
    v_mul_f32 v81, 0x3e800000, v81
    v_mul_f32 v82, 0x3e800000, v82
    v_mul_f32 v83, 0x3e800000, v83
    v_mul_f32 v84, 0x3e800000, v84
    v_mul_f32 v85, 0x3e800000, v85
    v_mul_f32 v86, 0x3e800000, v86
    v_mul_f32 v87, 0x3e800000, v87
    v_cvt_pk_f16_f32 v92, v80, v81
    v_cvt_pk_f16_f32 v93, v82, v83
    v_cvt_pk_f16_f32 v94, v84, v85
    v_cvt_pk_f16_f32 v95, v86, v87
    ds_write_b128 v96, v[92:95] offset:47104
    v_mul_f32 v78, 0x3d800000, v76
    v_mov_b32_e64 v98, 0
    v_mul_f32 v79, 4.0, v77
    v_mul_f32 v79, v79, v78
    v_add_f32 v79, v79, v98
    v_add_f32 v99, 0xbe800000, v79
    v_cos_f32 v80, v79
    v_cos_f32 v81, v99
    v_add_f32 v79, v79, v78
    v_add_f32 v99, 0xbe800000, v79
    v_cos_f32 v82, v79
    v_cos_f32 v83, v99
    v_add_f32 v79, v79, v78
    v_add_f32 v99, 0xbe800000, v79
    v_cos_f32 v84, v79
    v_cos_f32 v85, v99
    v_add_f32 v79, v79, v78
    v_add_f32 v99, 0xbe800000, v79
    v_cos_f32 v86, v79
    v_cos_f32 v87, v99
    v_mul_f32 v80, 0x3e800000, v80
    v_mul_f32 v81, 0x3e800000, v81
    v_mul_f32 v82, 0x3e800000, v82
    v_mul_f32 v83, 0x3e800000, v83
    v_mul_f32 v84, 0x3e800000, v84
    v_mul_f32 v85, 0x3e800000, v85
    v_mul_f32 v86, 0x3e800000, v86
    v_mul_f32 v87, 0x3e800000, v87
    v_cvt_pk_f16_f32 v92, v80, v81
    v_cvt_pk_f16_f32 v93, v82, v83
    v_cvt_pk_f16_f32 v94, v84, v85
    v_cvt_pk_f16_f32 v95, v86, v87
    ds_write_b128 v96, v[92:95] offset:0
    s_branch L_gjoin_2
L_gw_9:
    v_mul_f32 v78, 0x3d800000, v76
    v_mov_b32 v98, 0x3e800000
    v_mul_f32 v79, 4.0, v77
    v_mul_f32 v79, v79, v78
    v_add_f32 v79, v79, v98
    v_add_f32 v99, 0xbe800000, v79
    v_cos_f32 v80, v79
    v_cos_f32 v81, v99
    v_add_f32 v79, v79, v78
    v_add_f32 v99, 0xbe800000, v79
    v_cos_f32 v82, v79
    v_cos_f32 v83, v99
    v_add_f32 v79, v79, v78
    v_add_f32 v99, 0xbe800000, v79
    v_cos_f32 v84, v79
    v_cos_f32 v85, v99
    v_add_f32 v79, v79, v78
    v_add_f32 v99, 0xbe800000, v79
    v_cos_f32 v86, v79
    v_cos_f32_e64 v87, v99
    v_mul_f32 v80, 0x3e800000, v80
    v_mul_f32 v81, 0x3e800000, v81
    v_mul_f32 v82, 0x3e800000, v82
    v_mul_f32 v83, 0x3e800000, v83
    v_mul_f32 v84, 0x3e800000, v84
    v_mul_f32 v85, 0x3e800000, v85
    v_mul_f32 v86, 0x3e800000, v86
    v_mul_f32 v87, 0x3e800000, v87
    v_cvt_pk_f16_f32 v92, v80, v81
    v_cvt_pk_f16_f32 v93, v82, v83
    v_cvt_pk_f16_f32 v94, v84, v85
    v_cvt_pk_f16_f32 v95, v86, v87
    ds_write_b128 v96, v[92:95] offset:1024
L_gjoin_2:
    s_mul_i32 s43, s40, 288
    s_add_u32 s43, s43, 7168
    v_lshlrev_b32_e64 v76, 4, v2
    v_lshl_add_u32 v76, v3, 2, v76
    v_add_u32 v64, s43, v76
    s_lshl_b32 s43, s40, 5
    s_add_u32 s43, s43, 7168
    v_mul_u32_u24 v76, 2432, v3
    v_lshrrev_b32 v77, 2, v2
    v_mul_u32_u24 v77, 288, v77
    v_add_u32 v76, v76, v77
    v_and_b32 v77, 3, v2
    v_lshl_add_u32 v76, v77, 3, v76
    v_add_u32 v65, s43, v76
    v_lshrrev_b32_e64 v76, 2, v2
    v_lshl_add_u32 v76, v3, 5, v76
    v_mul_u32_u24 v76, 8448, v76
    v_and_b32_e64 v77, 3, v2
    v_lshl_add_u32 v66, v77, 4, v76
    s_mul_i32 s43, s40, 1040
    s_add_u32 s43, s43, 34816
    v_lshlrev_b32 v76, 4, v1
    v_add_u32 v67, s43, v76
    v_lshrrev_b32 v76, 3, v1
    v_lshlrev_b32 v79, 4, v76
    v_bfe_u32 v76, v1, 2, 1
    v_add_u32 v79, v79, v76
    s_lshl_b32 s43, s40, 1
    v_add_u32 v79, s43, v79
    v_and_b32 v80, 3, v1
    v_lshlrev_b32 v76, 6, v79
    v_lshl_add_u32 v70, v80, 4, v76
    v_and_b32 v76, 15, v79
    v_lshlrev_b32 v76, 4, v76
    v_lshrrev_b32 v77, 4, v79
    v_add_u32 v76, v76, v77
    v_mul_u32_u24 v77, 260, v80
    v_add_u32 v76, v76, v77
    v_lshlrev_b32_e64 v76, 2, v76
    v_add_u32 v68, 17152, v76
    v_sub_u32 v78, 256, v79
    v_and_b32 v78, 255, v78
    v_and_b32_e64 v76, 15, v78
    v_lshlrev_b32 v76, 4, v76
    v_lshrrev_b32 v77, 4, v78
    v_add_u32 v76, v76, v77
    v_mul_u32_u24 v77, 260, v80
    v_add_u32 v76, v76, v77
    v_lshlrev_b32 v76, 2, v76
    v_add_u32 v69, 17152, v76
    s_lshr_b32 s54, s2, 5
    s_and_b32 s43, s2, 31
    s_lshr_b32 s44, s43, 1
    s_and_b32 s45, s43, 1
    s_lshl_b32 s46, s45, 4
    s_add_u32 s55, s46, s44
    s_sub_u32 s44, 16, s44
    s_and_b32 s44, s44, 15
    s_sub_u32 s45, 3, s45
    s_lshl_b32 s45, s45, 4
    s_add_u32 s56, s45, s44
    s_lshl_b32 s55, s55, 7
    s_lshl_b32 s56, s56, 7
    v_bfe_u32 v76, v0, 3, 5
    v_lshrrev_b32 v77, 8, v0
    v_lshlrev_b32 v77, 2, v77
    v_add_u32 v77, s54, v77
    v_lshl_add_u32 v79, v76, 3, v77
    v_and_b32 v80, 7, v0
    v_mul_u32_u24 v81, 8448, v79
    v_lshl_add_u32 v81, v80, 4, v81
    v_add_u32_e64 v81, s55, v81
    v_sub_u32 v76, 256, v79
    v_mul_u32_u24 v82, 8448, v76
    v_sub_u32_e64 v76, 7, v80
    v_lshl_add_u32 v82, v76, 4, v82
    v_add_u32 v82, s56, v82
    s_movk_i32 s43, 128
    v_cmp_lt_u32 s[48:49], s43, v79
    s_nop 1
    v_cndmask_b32 v71, v81, v82, s[48:49]
    s_waitcnt lgkmcnt(0)
    s_barrier
    v_cmp_eq_u32 vcc, 0, v2
    v_mov_b32 v76, 0x3c00
    v_mov_b32 v77, 0xbc00
    v_cndmask_b32 v72, 0, v76, vcc
    v_cndmask_b32 v73, 0, v77, vcc
    v_mov_b32 v74, v72
    v_mov_b32 v75, v73
    v_lshlrev_b32_e64 v76, 4, v1
    ds_read_b128 v[20:23], v76 offset:36864
    ds_read_b128 v[24:27], v76 offset:37888
    ds_read_b128 v[28:31], v76 offset:38912
    ds_read_b128 v[32:35], v76 offset:39936
    ds_read_b128 v[36:39], v76 offset:40960
    ds_read_b128 v[40:43], v76 offset:41984
    ds_read_b128 v[44:47], v76 offset:43008
    ds_read_b128 v[48:51], v76 offset:44032
    ds_read_b128 v[52:55], v76 offset:45056
    ds_read_b128 v[56:59], v76 offset:46080
    ds_read_b128 v[60:63], v76 offset:47104
    s_mul_i32 s43, s40, 2304
    s_add_u32 s43, s43, 17152
    s_add_u32 s44, s43, 1152
    v_lshlrev_b32 v87, 4, v1
    v_lshl_add_u32 v87, v3, 5, v87
    v_add_u32 v87, s43, v87
    v_mul_u32_u24 v90, 288, v3
    v_lshl_add_u32 v84, v2, 1, v90
    v_add_u32 v84, s43, v84
    v_sub_u32 v90, 3, v3
    v_mul_u32_u24 v90, 288, v90
    v_sub_u32 v91, 16, v2
    v_lshl_add_u32 v85, v91, 1, v90
    v_add_u32 v85, s44, v85
    v_sub_u32 v90, 4, v3
    v_and_b32 v90, 3, v90
    v_mul_u32_u24 v90, 288, v90
    v_add_u32 v90, s44, v90
    v_add_u32 v86, 224, v85
    v_cmp_eq_u32 vcc, 0, v2
    s_nop 1
    v_cndmask_b32 v86, v86, v90, vcc
    v_mov_b32 v4, 0
    v_mov_b32 v12, 0
    v_mov_b32 v5, 0
    v_mov_b32 v13, 0
    v_mov_b32 v6, 0
    v_mov_b32 v14, 0
    v_mov_b32 v7, 0
    v_mov_b32 v15, 0
    v_mov_b32 v8, 0
    v_mov_b32 v16, 0
    v_mov_b32 v9, 0
    v_mov_b32 v17, 0
    v_mov_b32 v10, 0
    v_mov_b32 v18, 0
    v_mov_b32 v11, 0
    v_mov_b32 v19, 0
    v_mov_b32 v92, 0x3f803f80
    s_mul_i32 s66, s40, 33792
    s_lshl_b32 s44, s2, 6
    s_add_u32 s66, s66, s44
    s_add_u32 s66, s66, 0
    s_add_u32 s67, s44, 1081344
    s_lshl_b32 s43, s40, 1
    s_add_u32 s43, s43, 16896
    v_mov_b32_e64 v121, s43
    v_lshlrev_b32 v122, 4, v3
    s_waitcnt vmcnt(0)
    ds_write_b128 v87, v[112:115]
    ds_write_b128 v87, v[116:119] offset:1152
    v_dot2_f32_bf16 v93, v112, v92, 0
    v_dot2_f32_bf16 v95, v112, v112, 0
    v_dot2_f32_bf16 v94, v116, v92, 0
    v_dot2_f32_bf16 v96, v116, v116, 0
    v_dot2_f32_bf16 v93, v113, v92, v93
    v_dot2_f32_bf16 v95, v113, v113, v95
    v_dot2_f32_bf16 v94, v117, v92, v94
    v_dot2_f32_bf16 v96, v117, v117, v96
    v_dot2_f32_bf16 v93, v114, v92, v93
    v_dot2_f32_bf16 v95, v114, v114, v95
    v_dot2_f32_bf16 v94, v118, v92, v94
    v_dot2_f32_bf16 v96, v118, v118, v96
    v_dot2_f32_bf16 v93, v115, v92, v93
    v_dot2_f32_bf16 v95, v115, v115, v95
    v_dot2_f32_bf16 v94, v119, v92, v94
    v_dot2_f32_bf16 v96, v119, v119, v96
    s_waitcnt lgkmcnt(0)
    ds_read_u16_d16_hi v4, v84 offset:0
    s_nop 0
    ds_read_u16_d16_hi v5, v84 offset:32
    ds_read_u16_d16_hi v6, v84 offset:64
    ds_read_u16_d16_hi v7, v84 offset:96
    ds_read_u16_d16_hi v8, v84 offset:128
    ds_read_u16_d16_hi v9, v84 offset:160
    ds_read_u16_d16_hi v10, v84 offset:192
    ds_read_u16_d16_hi v11, v84 offset:224
    ds_read_u16_d16_hi v12, v86
    ds_read_u16_d16_hi v13, v85 offset:192
    ds_read_u16_d16_hi v14, v85 offset:160
    ds_read_u16_d16_hi v15, v85 offset:128
    ds_read_u16_d16_hi v16, v85 offset:96
    ds_read_u16_d16_hi v17, v85 offset:64
    ds_read_u16_d16_hi v18, v85 offset:32
    ds_read_u16_d16_hi v19, v85 offset:0
    v_permlane32_swap_b32 v93, v94
    v_permlane32_swap_b32 v95, v96
    v_add_f32 v93, v93, v94
    v_add_f32 v95, v95, v96
    s_nop 1
    v_permlane16_swap_b32 v93, v95
    v_add_f32 v93, v93, v95
    s_nop 1
    v_add_f32_dpp v93, v93, v93 row_ror:8 row_mask:0xf bank_mask:0xf
    s_nop 1
    v_add_f32_dpp v93, v93, v93 row_ror:4 row_mask:0xf bank_mask:0xf
    s_nop 1
    v_add_f32_dpp v93, v93, v93 row_ror:2 row_mask:0xf bank_mask:0xf
    s_nop 1
    v_add_f32_dpp v93, v93, v93 row_ror:1 row_mask:0xf bank_mask:0xf
    v_mov_b32 v98, v93
    s_nop 1
    v_permlane16_swap_b32 v93, v98
    v_mul_f32 v97, 0x3b000000, v93
    v_mul_f32 v98, 0x3b000000, v98
    v_fma_f32 v98, -v97, v97, v98
    v_max_f32 v98, 0, v98
    v_add_f32 v99, 0x3727c5ac, v98
    v_rsq_f32 v99, v99
    s_nop 0
    v_mul_f32 v101, v97, v99
    v_mov_b32 v100, v99
    s_nop 1
    v_permlane32_swap_b32 v99, v100
    v_mov_b32 v102, v101
    s_nop 1
    v_permlane32_swap_b32 v101, v102
    v_add_f32 v101, v101, v102
    s_waitcnt lgkmcnt(0)
    s_cmp_lg_u32 s40, 0
    s_cbranch_scc1 L_b0p_11
    v_and_b32 v120, 1, v1
    v_lshlrev_b32 v120, 6, v120
    v_add_u32 v120, 128, v120
    buffer_load_dword v120, v120, s[20:23], 0 offen sc1
L_b0p_11:
    v_fma_f32 v76, v12, v100, -v101
    v_fma_f32 v77, v13, v100, -v101
    v_fma_f32 v78, v14, v100, -v101
    v_fma_f32 v79, v15, v100, -v101
    v_fma_f32 v80, v16, v100, -v101
    v_fma_f32 v81, v17, v100, -v101
    v_fma_f32 v82, v18, v100, -v101
    v_fma_f32 v83, v19, v100, -v101
    v_fmac_f32 v76, v4, v99
    v_fmac_f32 v77, v5, v99
    v_fmac_f32 v78, v6, v99
    v_fmac_f32 v79, v7, v99
    v_fmac_f32 v80, v8, v99
    v_fmac_f32 v81, v9, v99
    v_fmac_f32 v82, v10, v99
    v_fmac_f32 v83, v11, v99
    v_cvt_pk_f16_f32 v84, v76, v77
    v_cvt_pk_f16_f32 v85, v78, v79
    v_cvt_pk_f16_f32 v86, v80, v81
    v_cvt_pk_f16_f32 v87, v82, v83
    s_nop 1
    v_mfma_f32_16x16x32_f16 v[88:91], v[84:87], v[20:23], 0
    v_mfma_f32_16x16x32_f16 v[92:95], v[84:87], v[24:27], 0
    v_mfma_f32_16x16x32_f16 v[96:99], v[84:87], v[28:31], 0
    v_mfma_f32_16x16x32_f16 v[100:103], v[84:87], v[32:35], 0
    s_nop 4
    v_pk_mul_f32 v[76:77], v[88:89], v[36:37]
    v_pk_mul_f32 v[80:81], v[92:93], v[36:37]
    v_pk_mul_f32 v[78:79], v[90:91], v[38:39]
    v_pk_mul_f32 v[82:83], v[94:95], v[38:39]
    v_pk_fma_f32 v[76:77], v[92:93], v[40:41], v[76:77]
    v_pk_fma_f32 v[80:81], v[88:89], v[40:41], v[80:81] neg_lo:[1,0,0] neg_hi:[1,0,0]
    v_pk_fma_f32 v[78:79], v[94:95], v[42:43], v[78:79]
    v_pk_fma_f32 v[82:83], v[90:91], v[42:43], v[82:83] neg_lo:[1,0,0] neg_hi:[1,0,0]
    v_cvt_pk_f16_f32 v84, v76, v80
    v_cvt_pk_f16_f32 v85, v77, v81
    v_cvt_pk_f16_f32 v86, v78, v82
    v_cvt_pk_f16_f32 v87, v79, v83
    s_nop 1
    s_nop 0
    v_mfma_f32_16x16x32_f16 v[88:91], v[52:55], v[84:87], 0
    v_mfma_f32_16x16x32_f16 v[92:95], v[72:75], v[84:87], 0
    v_pk_mul_f32 v[76:77], v[96:97], v[44:45]
    v_pk_mul_f32 v[80:81], v[100:101], v[44:45]
    v_pk_mul_f32 v[78:79], v[98:99], v[46:47]
    v_pk_mul_f32 v[82:83], v[102:103], v[46:47]
    v_pk_fma_f32 v[76:77], v[100:101], v[48:49], v[76:77]
    v_pk_fma_f32 v[80:81], v[96:97], v[48:49], v[80:81] neg_lo:[1,0,0] neg_hi:[1,0,0]
    v_pk_fma_f32 v[78:79], v[102:103], v[50:51], v[78:79]
    v_pk_fma_f32 v[82:83], v[98:99], v[50:51], v[82:83] neg_lo:[1,0,0] neg_hi:[1,0,0]
    v_cvt_pk_f16_f32 v84, v76, v80
    v_cvt_pk_f16_f32 v85, v77, v81
    v_cvt_pk_f16_f32 v86, v78, v82
    v_cvt_pk_f16_f32 v87, v79, v83
    s_nop 1
    v_mfma_f32_16x16x32_f16 v[96:99], v[52:55], v[84:87], 0
    v_cvt_pk_f16_f32 v76, v88, v90
    v_cvt_pk_f16_f32 v77, v89, v91
    ds_write_b32 v64, v76 offset:0
    ds_write_b32 v64, v77 offset:4864
    s_nop 3
    v_cvt_pk_f16_f32 v78, v96, v98
    v_cvt_pk_f16_f32 v79, v97, v99
    ds_write_b32 v64, v78 offset:2432
    ds_write_b32 v64, v79 offset:7296
    v_cvt_pk_f16_f32 v92, v92, v92
    s_mov_b64 exec, 1
    ds_write_b16 v121, v92
    s_mov_b64 exec, -1
    s_waitcnt vmcnt(0)
    s_cmp_lg_u32 s40, 0
    s_cbranch_scc1 L_b0w_12
    v_cmp_eq_u32 vcc, 0, v120
    s_cbranch_vccz L_pcd_14
    s_mov_b32 s47, 524288
    v_and_b32 v126, 1, v1
    v_lshlrev_b32_e64 v126, 6, v126
    v_add_u32 v126, 128, v126
L_pc_13:
    buffer_load_dword v127, v126, s[20:23], 0 offen sc1
    s_waitcnt vmcnt(0)
    v_cmp_eq_u32 vcc, 0, v127
    s_cbranch_vccz L_pcd_14
    s_sub_u32 s47, s47, 1
    s_cmp_lg_u32 s47, 0
    s_cbranch_scc1 L_pc_13
    v_mov_b32 v124, 1
    v_mov_b32 v123, 60
    buffer_store_dword v124, v123, s[20:23], 0 offen
L_pcd_14:
L_b0w_12:
    s_waitcnt lgkmcnt(0)
    s_barrier
    ds_read_b64_tr_b16 v[80:81], v65
    ds_read_b64_tr_b16 v[82:83], v65 offset:1152
    s_cmp_eq_u32 s40, 4
    s_cbranch_scc1 L_ny_15
    s_waitcnt lgkmcnt(0)
    v_mfma_f32_16x16x32_f16 v[84:87], v[56:59], v[80:83], 0
    v_mfma_f32_16x16x32_f16 v[88:91], v[60:63], v[80:83], 0
    s_nop 6
    v_cvt_pk_f16_f32 v96, v84, v85
    v_cvt_pk_f16_f32 v97, v86, v87
    v_cvt_pk_f16_f32 v98, v88, v89
    v_cvt_pk_f16_f32 v99, v90, v91
    buffer_store_dwordx4 v[96:99], v66, s[12:15], s66 offen sc1
    s_branch L_nye_16
L_ny_15:
    v_mov_b32 v116, 16896
    ds_read_b128 v[100:103], v116
    v_cmp_eq_u32 vcc, 0, v3
    s_waitcnt lgkmcnt(0)
    v_mfma_f32_16x16x32_f16 v[84:87], v[56:59], v[80:83], 0
    v_mfma_f32_16x16x32_f16 v[88:91], v[60:63], v[80:83], 0
    v_cndmask_b32 v100, 0, v100, vcc
    v_cndmask_b32 v101, 0, v101, vcc
    v_cndmask_b32 v102, 0, v102, vcc
    v_cndmask_b32 v103, 0, v103, vcc
    s_nop 1
    v_mfma_f32_16x16x32_f16 v[104:107], v[56:59], v[100:103], 0
    v_mfma_f32_16x16x32_f16 v[108:111], v[60:63], v[100:103], 0
    v_cvt_pk_f16_f32 v96, v84, v85
    v_cvt_pk_f16_f32 v97, v86, v87
    v_cvt_pk_f16_f32 v98, v88, v89
    v_cvt_pk_f16_f32 v99, v90, v91
    buffer_store_dwordx4 v[96:99], v66, s[12:15], s66 offen sc1
    v_cmp_eq_u32 vcc, 0, v2
    s_nop 0
    v_cvt_pk_f16_f32 v112, v104, v105
    v_cvt_pk_f16_f32 v113, v106, v107
    v_cvt_pk_f16_f32 v114, v108, v109
    v_cvt_pk_f16_f32 v115, v110, v111
    s_and_saveexec_b64 s[86:87], vcc
    buffer_store_dwordx4 v[112:115], v122, s[12:15], s67 offen sc1
    s_mov_b64 exec, s[86:87]
L_nye_16:
    s_cmp_lg_u32 s40, 7
    s_cbranch_scc1 L_wr_17
    v_lshlrev_b32_e64 v76, 4, v1
    buffer_load_dwordx4 v[108:111], v76, s[24:27], 0 offen
    v_lshlrev_b32 v76, 5, v1
    v_lshl_add_u32 v76, v3, 6, v76
    s_waitcnt vmcnt(0)
    v_lshlrev_b32 v84, 16, v108
    v_and_b32 v85, 0xffff0000, v108
    v_lshlrev_b32 v86, 16, v109
    v_and_b32 v87, 0xffff0000, v109
    v_lshlrev_b32 v88, 16, v110
    v_and_b32 v89, 0xffff0000, v110
    v_lshlrev_b32 v90, 16, v111
    v_and_b32 v91, 0xffff0000, v111
    ds_write_b128 v76, v[84:87] offset:4096
    ds_write_b128 v76, v[88:91] offset:4112
L_wr_17:
    s_mov_b32 s76, 0
    s_mov_b32 s77, 1277952
    s_mov_b32 s78, 0
L_col:
    s_cmp_lg_u32 s78, 0
    s_cbranch_scc1 L_cf1_18
    s_mul_i32 s43, s2, 3328
    s_add_u32 s43, s43, 4620288
    v_lshlrev_b32 v80, 4, v0
    v_mov_b32 v76, -1
    v_mov_b32 v77, -1
    v_mov_b32 v78, -1
    v_mov_b32 v79, -1
    s_movk_i32 s44, 193
    v_cmp_gt_u32 vcc, s44, v0
    s_and_saveexec_b64 s[86:87], vcc
    s_cbranch_execz L_po_19
    buffer_store_dwordx4 v[76:79], v80, s[12:15], s43 offen sc1
L_po_19:
    s_mov_b64 exec, s[86:87]
L_cf1_18:
    v_lshlrev_b32_e64 v92, 4, v1
    ds_read_b128 v[104:107], v92 offset:0
    ds_read_b128 v[108:111], v92 offset:1024
    ds_read_b128 v[112:115], v92 offset:2048
    ds_read_b128 v[116:119], v92 offset:3072
    v_and_b32 v93, 3, v1
    v_lshlrev_b32 v93, 4, v93
    v_add_u32 v93, 8192, v93
    v_mul_u32_u24 v96, 1040, v1
    v_add_u32 v96, 17184, v96
    s_mul_i32 s43, s40, 1040
    s_add_u32 s43, s43, 17152
    v_lshlrev_b32 v120, 6, v2
    v_lshl_add_u32 v120, v3, 4, v120
    v_add_u32 v120, s43, v120
    s_mul_i32 s43, s40, 1152
    s_add_u32 s43, s43, 25600
    v_mul_u32_u24 v121, 72, v3
    v_add_u32_e64 v121, v121, v2
    v_lshlrev_b32 v121, 2, v121
    v_add_u32 v121, s43, v121
    s_lshr_b32 s43, s40, 2
    s_mul_i32 s43, s43, 4608
    s_and_b32 s44, s40, 3
    s_lshl_b32 s44, s44, 5
    s_add_u32 s43, s43, s44
    s_add_u32 s43, s43, 25600
    v_and_b32 v122, 7, v1
    v_mul_u32_u24 v122, 36, v122
    v_lshrrev_b32 v80, 3, v1
    v_add_u32 v122, v122, v80
    v_lshlrev_b32 v122, 2, v122
    v_add_u32 v122, s43, v122
    s_cmp_lg_u32 s78, 0
    s_cbranch_scc1 L_cf1_20
    s_cmp_lg_u32 s40, 0
    s_cbranch_scc1 L_b0p_21
    v_and_b32 v124, 1, v1
    v_lshlrev_b32 v124, 6, v124
    v_add_u32 v124, 136, v124
    buffer_load_dword v124, v124, s[20:23], 0 offen sc1
L_b0p_21:
L_cf1_20:
    s_or_b32 s52, s78, s40
    s_mov_b32 s66, s77
    s_mul_i32 s43, s2, 8448
    s_add_u32 s43, s43, s76
    s_waitcnt vmcnt(0)
    s_mov_b32 s47, 524288
L_poll_22:
    buffer_load_dwordx4 v[76:79], v70, s[12:15], s43 offen sc1
    buffer_load_dwordx4 v[80:83], v93, s[12:15], s43 offen sc1
    s_waitcnt vmcnt(0)
    v_max3_u32 v126, v76, v77, v78
    v_max3_u32 v126, v126, v79, v80
    v_max3_u32 v126, v126, v81, v82
    v_max_u32 v126, v126, v83
    v_cmp_eq_u32 vcc, -1, v126
    s_cbranch_vccz L_pdone_23
    s_mov_b64 exec, vcc
    s_sub_u32 s47, s47, 1
    s_cmp_lg_u32 s47, 0
    s_cbranch_scc1 L_poll_22
    v_mov_b32_e64 v124, 2
    v_mov_b32 v123, 60
    buffer_store_dword v124, v123, s[20:23], 0 offen
L_pdone_23:
    s_mov_b64 exec, -1
    ds_write_b32 v68, v76
    ds_write_b32 v69, v77
    ds_write_b32 v68, v78 offset:4160
    ds_write_b32 v69, v79 offset:4160
    s_cmp_lg_u32 s40, 0
    s_cbranch_scc1 L_cx_24
    s_mov_b64 exec, 15
    ds_write_b32 v96, v80
    ds_write_b32 v96, v82 offset:4160
    s_mov_b64 exec, -1
L_cx_24:
    s_waitcnt lgkmcnt(0)
    s_barrier
    ds_read_b128 v[80:83], v120
    s_waitcnt lgkmcnt(0)
    v_mfma_f32_16x16x32_f16 v[84:87], v[80:83], v[104:107], 0
    v_mfma_f32_16x16x32_f16 v[88:91], v[80:83], v[108:111], 0
    s_nop 6
    v_pk_mul_f32 v[92:93], v[84:85], v[112:113]
    v_pk_mul_f32 v[96:97], v[88:89], v[112:113]
    v_pk_mul_f32 v[94:95], v[86:87], v[114:115]
    v_pk_mul_f32 v[98:99], v[90:91], v[114:115]
    v_pk_fma_f32 v[92:93], v[88:89], v[116:117], v[92:93]
    v_pk_fma_f32 v[96:97], v[84:85], v[116:117], v[96:97] neg_lo:[1,0,0] neg_hi:[1,0,0]
    v_pk_fma_f32 v[94:95], v[90:91], v[118:119], v[94:95]
    v_pk_fma_f32 v[98:99], v[86:87], v[118:119], v[98:99] neg_lo:[1,0,0] neg_hi:[1,0,0]
    v_cvt_pk_f16_f32 v100, v92, v96
    v_cvt_pk_f16_f32 v101, v93, v97
    v_cvt_pk_f16_f32 v102, v94, v98
    v_cvt_pk_f16_f32 v103, v95, v99
    s_nop 1
    v_mfma_f32_16x16x32_f16 v[84:87], v[104:107], v[100:103], 0
    v_mfma_f32_16x16x32_f16 v[88:91], v[108:111], v[100:103], 0
    s_nop 7
    v_cvt_pk_f16_f32 v76, v84, v88
    v_cvt_pk_f16_f32 v77, v85, v89
    v_cvt_pk_f16_f32 v78, v86, v90
    v_cvt_pk_f16_f32 v79, v87, v91
    ds_write_b32 v121, v76 offset:0
    ds_write_b32 v121, v77 offset:64
    ds_write_b32 v121, v78 offset:144
    ds_write_b32 v121, v79 offset:208
    s_cmp_lg_u32 s52, 0
    s_cbranch_scc1 L_b0w_25
    v_cmp_eq_u32 vcc, 0, v124
    s_cbranch_vccz L_pcd_27
    s_mov_b32 s47, 524288
    v_and_b32 v126, 1, v1
    v_lshlrev_b32 v126, 6, v126
    v_add_u32 v126, 136, v126
L_pc_26:
    buffer_load_dword v127, v126, s[20:23], 0 offen sc1
    s_waitcnt vmcnt(0)
    v_cmp_eq_u32 vcc, 0, v127
    s_cbranch_vccz L_pcd_27
    s_sub_u32 s47, s47, 1
    s_cmp_lg_u32 s47, 0
    s_cbranch_scc1 L_pc_26
    v_mov_b32 v124, 3
    v_mov_b32 v123, 60
    buffer_store_dword v124, v123, s[20:23], 0 offen
L_pcd_27:
L_b0w_25:
    s_waitcnt lgkmcnt(0)
    s_barrier
    s_cmp_eq_u32 s2, 128
    s_cbranch_scc1 L_cspec_28
    ds_read_b32 v84, v122 offset:0
    ds_read_b32 v85, v122 offset:1152
    ds_read_b32 v86, v122 offset:2304
    ds_read_b32 v87, v122 offset:3456
    s_waitcnt lgkmcnt(0)
    v_alignbit_b32 v88, v87, v87, 16
    v_alignbit_b32 v89, v86, v86, 16
    v_alignbit_b32 v90, v85, v85, 16
    v_alignbit_b32 v91, v84, v84, 16
    v_cndmask_b32 v92, v84, v88, s[48:49]
    v_cndmask_b32 v93, v85, v89, s[48:49]
    v_cndmask_b32 v94, v86, v90, s[48:49]
    v_cndmask_b32 v95, v87, v91, s[48:49]
    buffer_store_dwordx4 v[92:95], v71, s[12:15], s66 offen sc1
    s_cmp_gt_u32 s2, 31
    s_cbranch_scc1 L_cdone_29
    s_and_b32 s43, s40, 5
    s_cmp_lg_u32 s43, 0
    s_cbranch_scc1 L_cdone_29
    s_lshr_b32 s44, s40, 1
    s_sub_u32 s45, 8, s44
    v_sub_u32 v96, s45, v1
    v_and_b32 v96, 7, v96
    v_lshlrev_b32 v96, 4, v96
    s_mul_i32 s44, s44, 1081344
    s_add_u32 s44, s44, s56
    s_add_u32 s44, s44, s77
    s_mov_b64 exec, 0xff
    buffer_store_dwordx4 v[88:91], v96, s[12:15], s44 offen sc1
    s_mov_b64 exec, -1
    s_branch L_cdone_29
L_cspec_28:
    s_cmp_gt_u32 s40, 2
    s_cbranch_scc1 L_cdone_29
    v_and_b32 v96, 7, v0
    v_mul_u32_u24 v96, 288, v96
    v_lshrrev_b32 v97, 3, v0
    v_add_u32 v96, v96, v97
    v_lshlrev_b32 v96, 2, v96
    v_add_u32 v96, 25600, v96
    ds_read_b32 v84, v96 offset:0
    ds_read_b32 v85, v96 offset:144
    ds_read_b32 v86, v96 offset:288
    ds_read_b32 v87, v96 offset:432
    ds_read_b32 v88, v96 offset:576
    ds_read_b32 v89, v96 offset:720
    ds_read_b32 v90, v96 offset:864
    ds_read_b32 v91, v96 offset:1008
    v_mul_u32_u24 v97, 8448, v0
    v_add_u32 v97, 8192, v97
    s_mov_b32 s44, 0x05040100
    s_movk_i32 s45, 129
    v_cmp_gt_u32_e64 vcc, s45, v0
    s_waitcnt lgkmcnt(0)
    v_perm_b32 v92, v85, v84, s44
    v_perm_b32 v93, v87, v86, s44
    v_perm_b32 v94, v89, v88, s44
    v_perm_b32 v95, v91, v90, s44
    s_and_saveexec_b64 s[86:87], vcc
    s_mov_b32 s43, s77
    buffer_store_dwordx4 v[92:95], v97, s[12:15], s43 offen sc1
    s_mov_b64 exec, s[86:87]
L_cdone_29:
    s_cmp_lg_u32 s78, 0
    s_cbranch_scc1 L_k5
    s_mov_b32 s58, 0x42000000
    s_mov_b32 s50, 0
    s_mov_b32 s51, 0x00010001
    s_sub_u32 s68, 2047, s41
    s_lshl_b32 s68, s68, 1
    s_or_b32 s68, s68, 1
    s_sub_u32 s69, 2047, s42
    s_lshl_b32 s69, s69, 1
    s_mul_i32 s43, s2, 8448
    s_add_u32 s43, s43, 3506176
    v_lshlrev_b32 v80, 4, v0
    v_mov_b32 v76, -1
    v_mov_b32 v77, -1
    v_mov_b32 v78, -1
    v_mov_b32 v79, -1
    buffer_store_dwordx4 v[76:79], v80, s[12:15], s43 offen sc1
    s_add_u32 s43, s43, 8192
    s_movk_i32 s44, 2
    v_cmp_gt_u32_e64 vcc, s44, v0
    s_and_saveexec_b64 s[86:87], vcc
    s_cbranch_execz L_po_30
    buffer_store_dwordx4 v[76:79], v80, s[12:15], s43 offen sc1
L_po_30:
    s_mov_b64 exec, s[86:87]
    s_mul_i32 s43, s2, 3328
    s_add_u32 s43, s43, 5050368
    v_lshlrev_b32 v80, 4, v0
    v_mov_b32 v76, -1
    v_mov_b32 v77, -1
    v_mov_b32 v78, -1
    v_mov_b32 v79, -1
    s_movk_i32 s44, 193
    v_cmp_gt_u32 vcc, s44, v0
    s_and_saveexec_b64 s[86:87], vcc
    s_cbranch_execz L_po_31
    buffer_store_dwordx4 v[76:79], v80, s[12:15], s43 offen sc1
L_po_31:
    s_mov_b64 exec, s[86:87]
    s_mul_i32 s66, s40, 33792
    s_lshl_b32 s44, s2, 6
    s_add_u32 s66, s66, s44
    s_add_u32 s66, s66, 2392064
    s_add_u32 s67, s44, 3473408
    s_lshl_b32 s43, s40, 1
    s_add_u32 s43, s43, 16896
    v_mov_b32 v121, s43
    v_lshlrev_b32_e64 v100, 4, v3
    v_readfirstlane_b32 s70, v121
    s_mul_i32 s80, s2, 3328
    s_add_u32 s80, s80, 4620288
    s_lshl_b32 s81, s2, 5
    s_add_u32 s81, s81, 1090560
    v_mul_u32_u24 v87, 576, v3
    v_lshl_add_u32 v84, v2, 2, v87
    v_add_u32 v84, 4096, v84
    v_sub_u32 v87, 3, v3
    v_mul_u32_u24 v87, 576, v87
    v_sub_u32 v88, 16, v2
    v_lshl_add_u32 v85, v88, 2, v87
    v_add_u32 v85, 4096, v85
    v_sub_u32 v87, 4, v3
    v_and_b32 v87, 3, v87
    v_mul_u32_u24 v87, 576, v87
    v_add_u32 v87, 4096, v87
    v_add_u32 v86, 448, v85
    v_cmp_eq_u32 vcc, 0, v2
    s_nop 1
    v_cndmask_b32_e64 v86, v86, v87, vcc
    ds_read_b32 v104, v84 offset:0
    ds_read_b32 v105, v84 offset:64
    ds_read_b32 v106, v84 offset:128
    ds_read_b32 v107, v84 offset:192
    ds_read_b32 v108, v84 offset:256
    ds_read_b32 v109, v84 offset:320
    ds_read_b32 v110, v84 offset:384
    ds_read_b32 v111, v84 offset:448
    ds_read_b32 v112, v86
    ds_read_b32 v113, v85 offset:384
    ds_read_b32 v114, v85 offset:320
    ds_read_b32 v115, v85 offset:256
    ds_read_b32 v116, v85 offset:192
    ds_read_b32 v117, v85 offset:128
    ds_read_b32 v118, v85 offset:64
    ds_read_b32 v119, v85 offset:0
    s_waitcnt lgkmcnt(8)
    v_add_f32 v89, v104, v105
    v_add_f32 v89, v89, v106
    v_add_f32 v89, v89, v107
    v_add_f32 v89, v89, v108
    v_add_f32 v89, v89, v109
    v_add_f32 v89, v89, v110
    v_add_f32 v89, v89, v111
    s_nop 1
    v_add_f32_dpp v89, v89, v89 row_shr:1 row_mask:0xf bank_mask:0xf bound_ctrl:1
    s_nop 1
    v_add_f32_dpp v89, v89, v89 row_shr:2 row_mask:0xf bank_mask:0xf bound_ctrl:1
    s_nop 1
    v_add_f32_dpp v89, v89, v89 row_shr:4 row_mask:0xf bank_mask:0xf bound_ctrl:1
    s_nop 1
    v_add_f32_dpp v89, v89, v89 row_shr:8 row_mask:0xf bank_mask:0xf bound_ctrl:1
    s_nop 1
    v_add_f32_dpp v89, v89, v89 row_bcast:15 row_mask:0xa bank_mask:0xf
    s_nop 1
    v_add_f32_dpp v89, v89, v89 row_bcast:31 row_mask:0xc bank_mask:0xf
    s_nop 0
    v_readlane_b32 s57, v89, 63
    v_and_b32 v84, 7, v0
    v_mul_u32_u24 v84, 1040, v84
    v_lshrrev_b32 v85, 3, v0
    v_lshl_add_u32 v84, v85, 4, v84
    v_add_u32 v84, 34816, v84
    s_lshl_b32 s43, s40, 1
    s_add_u32 s43, s43, 43136
    s_mul_i32 s44, s40, 1040
    s_add_u32 s44, s44, 35342
    v_mov_b32_e64 v87, s43
    v_mov_b32 v85, s44
    v_cmp_eq_u32 vcc, 48, v1
    s_nop 1
    v_cndmask_b32 v87, v87, v85, vcc
    v_lshlrev_b32 v86, 4, v0
    v_mov_b32 v85, 0
    v_mov_b32 v120, 6400
    v_mov_b32 v89, 43136
    v_mov_b32 v122, s68
    v_mov_b32 v88, s69
    v_cmp_gt_u32 vcc, 32, v1
    s_nop 1
    v_cndmask_b32_e64 v122, v88, v122, vcc
    s_cmp_lg_u32 s40, 0
    s_cbranch_scc1 L_cz_32
    ds_write_b32 v120, v85
L_cz_32:
    s_mul_i32 s43, s2, 8448
    s_add_u32 s43, s43, 1277952
    s_add_u32 s44, s43, 8192
    s_waitcnt vmcnt(0)
    s_mov_b32 s47, 524288
L_poll_33:
    buffer_load_dwordx4 v[76:79], v86, s[12:15], s43 offen sc1
    buffer_load_dwordx4 v[80:83], v85, s[12:15], s44 offen sc1
    s_waitcnt vmcnt(0)
    v_max3_u32 v126, v76, v77, v78
    v_max3_u32 v126, v126, v79, v80
    v_max3_u32 v126, v126, v81, v82
    v_max_u32_e64 v126, v126, v83
    v_cmp_eq_u32 vcc, -1, v126
    s_cbranch_vccz L_pdone_34
    s_mov_b64 exec, vcc
    s_sub_u32 s47, s47, 1
    s_cmp_lg_u32 s47, 0
    s_cbranch_scc1 L_poll_33
    v_mov_b32 v124, 8
    v_mov_b32 v123, 60
    buffer_store_dword v124, v123, s[20:23], 0 offen
L_pdone_34:
    s_mov_b64 exec, -1
    ds_write_b128 v84, v[76:79]
    s_mov_b64 exec, 1
    ds_write_b128 v89, v[80:83]
    s_mov_b64 exec, -1
    s_waitcnt lgkmcnt(0)
    s_barrier
    ds_read_b128 v[76:79], v67
    ds_read_u16_d16_hi v80, v87
    s_waitcnt lgkmcnt(0)
    s_mov_b64 exec, s[50:51]
    v_alignbit_b32 v79, v79, v78, 16
    v_alignbit_b32 v78, v78, v77, 16
    v_alignbit_b32 v77, v77, v76, 16
    v_alignbit_b32 v76, v76, v80, 16
    s_mov_b64 exec, -1
    v_fma_mix_f32 v4, v76, s58, v4 op_sel:[0,0,0] op_sel_hi:[1,0,0]
    v_fma_mix_f32 v12, v76, s58, v12 op_sel:[0,0,0] op_sel_hi:[1,0,0]
    v_fma_mix_f32 v5, v76, s58, v5 op_sel:[1,0,0] op_sel_hi:[1,0,0]
    v_fma_mix_f32 v13, v76, s58, v13 op_sel:[1,0,0] op_sel_hi:[1,0,0]
    v_fma_mix_f32 v6, v77, s58, v6 op_sel:[0,0,0] op_sel_hi:[1,0,0]
    v_fma_mix_f32 v14, v77, s58, v14 op_sel:[0,0,0] op_sel_hi:[1,0,0]
    v_fma_mix_f32 v7, v77, s58, v7 op_sel:[1,0,0] op_sel_hi:[1,0,0]
    v_fma_mix_f32 v15, v77, s58, v15 op_sel:[1,0,0] op_sel_hi:[1,0,0]
    v_fma_mix_f32 v8, v78, s58, v8 op_sel:[0,0,0] op_sel_hi:[1,0,0]
    v_fma_mix_f32 v16, v78, s58, v16 op_sel:[0,0,0] op_sel_hi:[1,0,0]
    v_fma_mix_f32 v9, v78, s58, v9 op_sel:[1,0,0] op_sel_hi:[1,0,0]
    v_fma_mix_f32 v17, v78, s58, v17 op_sel:[1,0,0] op_sel_hi:[1,0,0]
    v_fma_mix_f32 v10, v79, s58, v10 op_sel:[0,0,0] op_sel_hi:[1,0,0]
    v_fma_mix_f32 v18, v79, s58, v18 op_sel:[0,0,0] op_sel_hi:[1,0,0]
    v_fma_mix_f32 v11, v79, s58, v11 op_sel:[1,0,0] op_sel_hi:[1,0,0]
    v_fma_mix_f32 v19, v79, s58, v19 op_sel:[1,0,0] op_sel_hi:[1,0,0]
    s_mov_b32 s84, 0
L_stats:
    v_add_f32 v80, v4, v5
    v_mul_f32 v82, v4, v4
    v_mul_f32 v84, v4, v104
    v_add_f32 v81, v12, v13
    v_mul_f32 v83, v12, v12
    v_mul_f32 v85, v12, v112
    v_fmac_f32 v82, v5, v5
    v_fmac_f32 v84, v5, v105
    v_fmac_f32 v83, v13, v13
    v_fmac_f32 v85, v13, v113
    v_add_f32 v80, v80, v6
    v_fmac_f32 v82, v6, v6
    v_fmac_f32 v84, v6, v106
    v_add_f32 v81, v81, v14
    v_fmac_f32 v83, v14, v14
    v_fmac_f32 v85, v14, v114
    v_add_f32 v80, v80, v7
    v_fmac_f32 v82, v7, v7
    v_fmac_f32 v84, v7, v107
    v_add_f32 v81, v81, v15
    v_fmac_f32 v83, v15, v15
    v_fmac_f32 v85, v15, v115
    v_add_f32 v80, v80, v8
    v_fmac_f32 v82, v8, v8
    v_fmac_f32 v84, v8, v108
    v_add_f32 v81, v81, v16
    v_fmac_f32 v83, v16, v16
    v_fmac_f32 v85, v16, v116
    v_add_f32 v80, v80, v9
    v_fmac_f32 v82, v9, v9
    v_fmac_f32 v84, v9, v109
    v_add_f32 v81, v81, v17
    v_fmac_f32 v83, v17, v17
    v_fmac_f32 v85, v17, v117
    v_add_f32 v80, v80, v10
    v_fmac_f32 v82, v10, v10
    v_fmac_f32 v84, v10, v110
    v_add_f32 v81, v81, v18
    v_fmac_f32 v83, v18, v18
    v_fmac_f32 v85, v18, v118
    v_add_f32 v80, v80, v11
    v_fmac_f32 v82, v11, v11
    v_fmac_f32 v84, v11, v111
    v_add_f32 v81, v81, v19
    v_fmac_f32 v83, v19, v19
    v_fmac_f32 v85, v19, v119
    v_permlane32_swap_b32 v80, v81
    v_permlane32_swap_b32 v82, v83
    v_permlane32_swap_b32 v84, v85
    v_add_f32 v80, v80, v81
    v_add_f32 v82, v82, v83
    v_add_f32 v84, v84, v85
    v_mov_b32 v86, v84
    v_permlane16_swap_b32 v80, v82
    s_nop 0
    v_permlane16_swap_b32 v84, v86
    v_add_f32 v80, v80, v82
    v_add_f32 v84, v84, v86
    s_nop 0
    v_add_f32_dpp v80, v80, v80 row_ror:8 row_mask:0xf bank_mask:0xf
    v_add_f32_dpp v84, v84, v84 row_ror:8 row_mask:0xf bank_mask:0xf
    s_nop 0
    v_add_f32_dpp v80, v80, v80 row_ror:4 row_mask:0xf bank_mask:0xf
    v_add_f32_dpp v84, v84, v84 row_ror:4 row_mask:0xf bank_mask:0xf
    s_nop 0
    v_add_f32_dpp v80, v80, v80 row_ror:2 row_mask:0xf bank_mask:0xf
    v_add_f32_dpp v84, v84, v84 row_ror:2 row_mask:0xf bank_mask:0xf
    s_nop 0
    v_add_f32_dpp v80, v80, v80 row_ror:1 row_mask:0xf bank_mask:0xf
    v_add_f32_dpp v84, v84, v84 row_ror:1 row_mask:0xf bank_mask:0xf
    v_mov_b32 v88, v80
    s_nop 1
    v_permlane16_swap_b32 v80, v88
    v_mul_f32 v87, 0x3b000000, v80
    v_mul_f32 v88, 0x3b000000, v88
    v_fma_f32 v88, -v87, v87, v88
    v_max_f32 v88, 0, v88
    v_add_f32 v89, 0x3727c5ac, v88
    v_rsq_f32 v89, v89
    v_fma_f32 v90, -v87, s57, v84
    v_mul_f32 v90, v90, v89
    v_ashrrev_i32 v92, 31, v90
    v_or_b32 v92, 0x80000000, v92
    v_xor_b32 v91, v90, v92
    v_and_b32 v91, 0xfffff000, v91
    v_or_b32 v91, v91, v122
    v_min_u32 v91, -2, v91
    s_mov_b32 exec_lo, 1
    s_mov_b32 exec_hi, 1
    ds_max_u32 v120, v91
    s_mov_b64 exec, -1
    s_waitcnt lgkmcnt(0)
    s_barrier
    ds_read_b32 v92, v120
    v_add_f32 v93, 1.0, v89
    v_mul_f32 v94, v87, v89
    v_mov_b32 v95, v93
    s_nop 1
    v_permlane32_swap_b32 v93, v95
    v_mov_b32 v96, v94
    s_nop 1
    v_permlane32_swap_b32 v94, v96
    s_waitcnt lgkmcnt(0)
    v_readfirstlane_b32 s59, v92
    s_and_b32 s45, s59, 0xfff
    s_cmp_lg_u32 s45, s68
    s_cbranch_scc1 L_pb_35
    v_mov_b32_e64 v103, s59
    v_mul_u32_u24 v102, 4352, v1
    s_mov_b64 exec, 15
    buffer_store_dword v103, v102, s[12:15], s81 offen sc1
    s_mov_b64 exec, -1
    v_fma_f32 v104, v4, v93, -v94
    v_fma_f32 v105, v5, v93, -v94
    v_fma_f32 v106, v6, v93, -v94
    v_fma_f32 v107, v7, v93, -v94
    v_fma_f32 v108, v8, v93, -v94
    v_fma_f32 v109, v9, v93, -v94
    v_fma_f32 v110, v10, v93, -v94
    v_fma_f32 v111, v11, v93, -v94
    v_sub_f32 v112, v104, v4
    v_sub_f32 v113, v105, v5
    v_sub_f32 v114, v106, v6
    v_sub_f32 v115, v107, v7
    v_sub_f32 v116, v108, v8
    v_sub_f32 v117, v109, v9
    v_sub_f32 v118, v110, v10
    v_sub_f32 v119, v111, v11
    v_readlane_b32 s46, v90, 0
    v_cvt_pk_bf16_f32 v76, v112, v113
    v_cvt_pk_bf16_f32 v77, v114, v115
    v_cvt_pk_bf16_f32 v78, v116, v117
    v_cvt_pk_bf16_f32 v79, v118, v119
    s_mov_b32 s45, s80
    v_lshlrev_b32 v102, 4, v1
    buffer_store_dwordx4 v[76:79], v102, s[12:15], s45 offen sc1
    v_mov_b32_e64 v103, s46
    buffer_store_dwordx4 v[104:107], v102, s[12:15], s45 offen offset:1024 sc1
    buffer_store_dwordx4 v[108:111], v102, s[12:15], s45 offen offset:2048 sc1
    v_mov_b32 v102, 0
    s_mov_b64 exec, 1
    buffer_store_dword v103, v102, s[12:15], s45 offen offset:3072 sc1
    s_mov_b64 exec, -1
L_pb_35:
    s_and_b32 s45, s59, 0xfff
    s_cmp_lg_u32 s45, s69
    s_cbranch_scc1 L_pb_36
    v_mov_b32 v103, s59
    v_mul_u32_u24 v102, 4352, v1
    s_mov_b64 exec, 15
    buffer_store_dword v103, v102, s[12:15], s81 offen sc1
    s_mov_b64 exec, -1
    v_fma_f32 v104, v12, v95, -v96
    v_fma_f32 v105, v13, v95, -v96
    v_fma_f32 v106, v14, v95, -v96
    v_fma_f32 v107, v15, v95, -v96
    v_fma_f32 v108, v16, v95, -v96
    v_fma_f32 v109, v17, v95, -v96
    v_fma_f32 v110, v18, v95, -v96
    v_fma_f32 v111, v19, v95, -v96
    v_sub_f32 v112, v104, v12
    v_sub_f32 v113, v105, v13
    v_sub_f32 v114, v106, v14
    v_sub_f32 v115, v107, v15
    v_sub_f32 v116, v108, v16
    v_sub_f32 v117, v109, v17
    v_sub_f32 v118, v110, v18
    v_sub_f32 v119, v111, v19
    v_readlane_b32 s46, v90, 32
    v_cvt_pk_bf16_f32 v76, v112, v113
    v_cvt_pk_bf16_f32 v77, v114, v115
    v_cvt_pk_bf16_f32 v78, v116, v117
    v_cvt_pk_bf16_f32 v79, v118, v119
    s_mov_b32 s45, s80
    v_lshlrev_b32 v102, 4, v1
    buffer_store_dwordx4 v[76:79], v102, s[12:15], s45 offen sc1
    v_mov_b32_e64 v103, s46
    buffer_store_dwordx4 v[104:107], v102, s[12:15], s45 offen offset:1024 sc1
    buffer_store_dwordx4 v[108:111], v102, s[12:15], s45 offen offset:2048 sc1
    v_mov_b32_e64 v102, 0
    s_mov_b64 exec, 1
    buffer_store_dword v103, v102, s[12:15], s45 offen offset:3072 sc1
    s_mov_b64 exec, -1
L_pb_36:
    s_cmp_lg_u32 s84, 0
    s_cbranch_scc1 L_k5_cont
    v_add_f32 v100, 1.0, v89
    v_mul_f32 v97, v100, v100
    v_mul_f32 v97, v97, v88
    v_add_f32 v97, 0x3727c5ac, v97
    v_rsq_f32 v97, v97
    s_nop 0
    v_mul_f32 v97, v97, v100
    v_mul_f32 v99, v87, v97
    v_mov_b32 v98, v97
    s_nop 1
    v_permlane32_swap_b32 v97, v98
    v_mov_b32 v101, v99
    s_nop 1
    v_permlane32_swap_b32 v99, v101
    v_add_f32 v99, v99, v101
    v_fma_f32 v76, v12, v98, -v99
    v_fma_f32 v77, v13, v98, -v99
    v_fma_f32 v78, v14, v98, -v99
    v_fma_f32 v79, v15, v98, -v99
    v_fma_f32 v80, v16, v98, -v99
    v_fma_f32 v81, v17, v98, -v99
    v_fma_f32 v82, v18, v98, -v99
    v_fma_f32 v83, v19, v98, -v99
    v_fmac_f32 v76, v4, v97
    v_fmac_f32 v77, v5, v97
    v_fmac_f32 v78, v6, v97
    v_fmac_f32 v79, v7, v97
    v_fmac_f32 v80, v8, v97
    v_fmac_f32 v81, v9, v97
    v_fmac_f32 v82, v10, v97
    v_fmac_f32 v83, v11, v97
    v_fma_f32 v4, v4, v93, -v94
    v_fma_f32 v5, v5, v93, -v94
    v_fma_f32 v6, v6, v93, -v94
    v_fma_f32 v7, v7, v93, -v94
    v_fma_f32 v8, v8, v93, -v94
    v_fma_f32 v9, v9, v93, -v94
    v_fma_f32 v10, v10, v93, -v94
    v_fma_f32 v11, v11, v93, -v94
    v_fma_f32 v12, v12, v95, -v96
    v_fma_f32 v13, v13, v95, -v96
    v_fma_f32 v14, v14, v95, -v96
    v_fma_f32 v15, v15, v95, -v96
    v_fma_f32 v16, v16, v95, -v96
    v_fma_f32 v17, v17, v95, -v96
    v_fma_f32 v18, v18, v95, -v96
    v_fma_f32 v19, v19, v95, -v96
    v_mov_b32 v121, s70
    v_lshlrev_b32 v122, 4, v3
    v_cvt_pk_f16_f32 v84, v76, v77
    v_cvt_pk_f16_f32 v85, v78, v79
    v_cvt_pk_f16_f32 v86, v80, v81
    v_cvt_pk_f16_f32 v87, v82, v83
    s_nop 1
    v_mfma_f32_16x16x32_f16 v[88:91], v[84:87], v[20:23], 0
    v_mfma_f32_16x16x32_f16 v[92:95], v[84:87], v[24:27], 0
    v_mfma_f32_16x16x32_f16 v[96:99], v[84:87], v[28:31], 0
    v_mfma_f32_16x16x32_f16 v[100:103], v[84:87], v[32:35], 0
    s_nop 4
    v_pk_mul_f32 v[76:77], v[88:89], v[36:37]
    v_pk_mul_f32 v[80:81], v[92:93], v[36:37]
    v_pk_mul_f32 v[78:79], v[90:91], v[38:39]
    v_pk_mul_f32 v[82:83], v[94:95], v[38:39]
    v_pk_fma_f32 v[76:77], v[92:93], v[40:41], v[76:77]
    v_pk_fma_f32 v[80:81], v[88:89], v[40:41], v[80:81] neg_lo:[1,0,0] neg_hi:[1,0,0]
    v_pk_fma_f32 v[78:79], v[94:95], v[42:43], v[78:79]
    v_pk_fma_f32 v[82:83], v[90:91], v[42:43], v[82:83] neg_lo:[1,0,0] neg_hi:[1,0,0]
    v_cvt_pk_f16_f32 v84, v76, v80
    v_cvt_pk_f16_f32 v85, v77, v81
    v_cvt_pk_f16_f32 v86, v78, v82
    v_cvt_pk_f16_f32 v87, v79, v83
    s_nop 1
    v_mfma_f32_16x16x32_f16 v[88:91], v[52:55], v[84:87], 0
    s_nop 0
    v_mfma_f32_16x16x32_f16 v[92:95], v[72:75], v[84:87], 0
    v_pk_mul_f32 v[76:77], v[96:97], v[44:45]
    v_pk_mul_f32 v[80:81], v[100:101], v[44:45]
    v_pk_mul_f32 v[78:79], v[98:99], v[46:47]
    v_pk_mul_f32 v[82:83], v[102:103], v[46:47]
    v_pk_fma_f32 v[76:77], v[100:101], v[48:49], v[76:77]
    v_pk_fma_f32 v[80:81], v[96:97], v[48:49], v[80:81] neg_lo:[1,0,0] neg_hi:[1,0,0]
    v_pk_fma_f32 v[78:79], v[102:103], v[50:51], v[78:79]
    v_pk_fma_f32 v[82:83], v[98:99], v[50:51], v[82:83] neg_lo:[1,0,0] neg_hi:[1,0,0]
    v_cvt_pk_f16_f32 v84, v76, v80
    v_cvt_pk_f16_f32 v85, v77, v81
    v_cvt_pk_f16_f32 v86, v78, v82
    v_cvt_pk_f16_f32 v87, v79, v83
    s_nop 1
    v_mfma_f32_16x16x32_f16 v[96:99], v[52:55], v[84:87], 0
    v_cvt_pk_f16_f32 v76, v88, v90
    v_cvt_pk_f16_f32 v77, v89, v91
    ds_write_b32 v64, v76 offset:0
    ds_write_b32 v64, v77 offset:4864
    s_nop 3
    v_cvt_pk_f16_f32 v78, v96, v98
    v_cvt_pk_f16_f32 v79, v97, v99
    ds_write_b32 v64, v78 offset:2432
    ds_write_b32 v64, v79 offset:7296
    v_cvt_pk_f16_f32 v92, v92, v92
    s_mov_b64 exec, 1
    ds_write_b16 v121, v92
    s_mov_b64 exec, -1
    s_waitcnt lgkmcnt(0)
    s_barrier
    ds_read_b64_tr_b16 v[80:81], v65
    ds_read_b64_tr_b16 v[82:83], v65 offset:1152
    s_cmp_eq_u32 s40, 4
    s_cbranch_scc1 L_ny_37
    s_waitcnt lgkmcnt(0)
    v_mfma_f32_16x16x32_f16 v[84:87], v[56:59], v[80:83], 0
    v_mfma_f32_16x16x32_f16 v[88:91], v[60:63], v[80:83], 0
    s_nop 6
    v_cvt_pk_f16_f32 v96, v84, v85
    v_cvt_pk_f16_f32 v97, v86, v87
    v_cvt_pk_f16_f32 v98, v88, v89
    v_cvt_pk_f16_f32 v99, v90, v91
    buffer_store_dwordx4 v[96:99], v66, s[12:15], s66 offen sc1
    s_branch L_nye_38
L_ny_37:
    v_mov_b32 v116, 16896
    ds_read_b128 v[100:103], v116
    v_cmp_eq_u32 vcc, 0, v3
    s_waitcnt lgkmcnt(0)
    v_mfma_f32_16x16x32_f16 v[84:87], v[56:59], v[80:83], 0
    v_mfma_f32_16x16x32_f16 v[88:91], v[60:63], v[80:83], 0
    v_cndmask_b32 v100, 0, v100, vcc
    v_cndmask_b32 v101, 0, v101, vcc
    v_cndmask_b32 v102, 0, v102, vcc
    v_cndmask_b32 v103, 0, v103, vcc
    s_nop 1
    v_mfma_f32_16x16x32_f16 v[104:107], v[56:59], v[100:103], 0
    v_mfma_f32_16x16x32_f16 v[108:111], v[60:63], v[100:103], 0
    v_cvt_pk_f16_f32 v96, v84, v85
    v_cvt_pk_f16_f32 v97, v86, v87
    v_cvt_pk_f16_f32 v98, v88, v89
    v_cvt_pk_f16_f32 v99, v90, v91
    buffer_store_dwordx4 v[96:99], v66, s[12:15], s66 offen sc1
    v_cmp_eq_u32 vcc, 0, v2
    s_nop 0
    v_cvt_pk_f16_f32 v112, v104, v105
    v_cvt_pk_f16_f32 v113, v106, v107
    v_cvt_pk_f16_f32 v114, v108, v109
    v_cvt_pk_f16_f32 v115, v110, v111
    s_and_saveexec_b64 s[86:87], vcc
    buffer_store_dwordx4 v[112:115], v122, s[12:15], s67 offen sc1
    s_mov_b64 exec, s[86:87]
L_nye_38:
    s_mov_b32 s76, 2392064
    s_mov_b32 s77, 3506176
    s_mov_b32 s78, 1
    s_branch L_col
L_k5:
    s_mul_i32 s80, s2, 3328
    s_add_u32 s80, s80, 5050368
    s_lshl_b32 s81, s2, 5
    s_add_u32 s81, s81, 1107968
    v_mul_u32_u24 v87, 576, v3
    v_lshl_add_u32 v84, v2, 2, v87
    v_add_u32 v84, 4096, v84
    v_sub_u32 v87, 3, v3
    v_mul_u32_u24 v87, 576, v87
    v_sub_u32_e64 v88, 16, v2
    v_lshl_add_u32 v85, v88, 2, v87
    v_add_u32 v85, 4096, v85
    v_sub_u32 v87, 4, v3
    v_and_b32 v87, 3, v87
    v_mul_u32_u24 v87, 576, v87
    v_add_u32 v87, 4096, v87
    v_add_u32 v86, 448, v85
    v_cmp_eq_u32 vcc, 0, v2
    s_nop 1
    v_cndmask_b32_e64 v86, v86, v87, vcc
    ds_read_b32 v104, v84 offset:0
    ds_read_b32 v105, v84 offset:64
    ds_read_b32 v106, v84 offset:128
    ds_read_b32 v107, v84 offset:192
    ds_read_b32 v108, v84 offset:256
    ds_read_b32 v109, v84 offset:320
    ds_read_b32 v110, v84 offset:384
    ds_read_b32 v111, v84 offset:448
    ds_read_b32 v112, v86
    ds_read_b32 v113, v85 offset:384
    ds_read_b32 v114, v85 offset:320
    ds_read_b32 v115, v85 offset:256
    ds_read_b32 v116, v85 offset:192
    ds_read_b32 v117, v85 offset:128
    ds_read_b32 v118, v85 offset:64
    ds_read_b32 v119, v85 offset:0
    v_and_b32_e64 v84, 7, v0
    v_mul_u32_u24 v84, 1040, v84
    v_lshrrev_b32 v85, 3, v0
    v_lshl_add_u32 v84, v85, 4, v84
    v_add_u32 v84, 34816, v84
    s_lshl_b32 s43, s40, 1
    s_add_u32 s43, s43, 43136
    s_mul_i32 s44, s40, 1040
    s_add_u32 s44, s44, 35342
    v_mov_b32 v87, s43
    v_mov_b32 v85, s44
    v_cmp_eq_u32 vcc, 48, v1
    s_nop 1
    v_cndmask_b32 v87, v87, v85, vcc
    v_lshlrev_b32 v86, 4, v0
    v_mov_b32_e64 v85, 0
    v_mov_b32 v120, 6404
    v_mov_b32 v89, 43136
    v_mov_b32_e64 v122, s68
    v_mov_b32 v88, s69
    v_cmp_gt_u32 vcc, 32, v1
    s_nop 1
    v_cndmask_b32 v122, v88, v122, vcc
    s_cmp_lg_u32 s40, 0
    s_cbranch_scc1 L_cz_39
    ds_write_b32 v120, v85
    s_and_b32 s43, s2, 15
    s_lshl_b32 s43, s43, 8
    s_add_u32 s43, s43, 1186816
    s_mov_b32 s47, 524288
L_ps_40:
    buffer_load_dword v88, v85, s[12:15], s43 offen sc1
    s_waitcnt vmcnt(0)
    v_cmp_eq_u32 vcc, -1, v88
    s_cbranch_vccz L_psd_41
    s_sub_u32 s47, s47, 1
    s_cmp_lg_u32 s47, 0
    s_cbranch_scc1 L_ps_40
    v_mov_b32 v124, 17
    v_mov_b32 v123, 60
    buffer_store_dword v124, v123, s[20:23], 0 offen
L_psd_41:
    v_mov_b32 v90, 6528
    ds_write_b32 v90, v88
L_cz_39:
    s_mul_i32 s43, s2, 8448
    s_add_u32 s43, s43, 3506176
    s_add_u32 s44, s43, 8192
    s_waitcnt vmcnt(0)
    s_mov_b32 s47, 524288
L_poll_42:
    buffer_load_dwordx4 v[76:79], v86, s[12:15], s43 offen sc1
    buffer_load_dwordx4 v[80:83], v85, s[12:15], s44 offen sc1
    s_waitcnt vmcnt(0)
    v_max3_u32 v126, v76, v77, v78
    v_max3_u32 v126, v126, v79, v80
    v_max3_u32 v126, v126, v81, v82
    v_max_u32 v126, v126, v83
    v_cmp_eq_u32 vcc, -1, v126
    s_cbranch_vccz L_pdone_43
    s_mov_b64 exec, vcc
    s_sub_u32 s47, s47, 1
    s_cmp_lg_u32 s47, 0
    s_cbranch_scc1 L_poll_42
    v_mov_b32 v124, 9
    v_mov_b32 v123, 60
    buffer_store_dword v124, v123, s[20:23], 0 offen
L_pdone_43:
    s_mov_b64 exec, -1
    ds_write_b128 v84, v[76:79]
    s_mov_b64 exec, 1
    ds_write_b128 v89, v[80:83]
    s_mov_b64 exec, -1
    s_waitcnt lgkmcnt(0)
    s_barrier
    ds_read_b128 v[76:79], v67
    ds_read_u16_d16_hi v80, v87
    v_mov_b32 v81, 6528
    ds_read_b32 v81, v81
    s_waitcnt lgkmcnt(0)
    s_mov_b64 exec, s[50:51]
    v_alignbit_b32 v79, v79, v78, 16
    v_alignbit_b32 v78, v78, v77, 16
    v_alignbit_b32 v77, v77, v76, 16
    v_alignbit_b32 v76, v76, v80, 16
    s_mov_b64 exec, -1
    v_fma_mix_f32 v4, v76, s58, v4 op_sel:[0,0,0] op_sel_hi:[1,0,0]
    s_nop 0
    v_fma_mix_f32 v12, v76, s58, v12 op_sel:[0,0,0] op_sel_hi:[1,0,0]
    v_fma_mix_f32 v5, v76, s58, v5 op_sel:[1,0,0] op_sel_hi:[1,0,0]
    v_fma_mix_f32 v13, v76, s58, v13 op_sel:[1,0,0] op_sel_hi:[1,0,0]
    v_fma_mix_f32 v6, v77, s58, v6 op_sel:[0,0,0] op_sel_hi:[1,0,0]
    v_fma_mix_f32 v14, v77, s58, v14 op_sel:[0,0,0] op_sel_hi:[1,0,0]
    v_fma_mix_f32 v7, v77, s58, v7 op_sel:[1,0,0] op_sel_hi:[1,0,0]
    v_fma_mix_f32 v15, v77, s58, v15 op_sel:[1,0,0] op_sel_hi:[1,0,0]
    v_fma_mix_f32 v8, v78, s58, v8 op_sel:[0,0,0] op_sel_hi:[1,0,0]
    v_fma_mix_f32 v16, v78, s58, v16 op_sel:[0,0,0] op_sel_hi:[1,0,0]
    v_fma_mix_f32 v9, v78, s58, v9 op_sel:[1,0,0] op_sel_hi:[1,0,0]
    v_fma_mix_f32 v17, v78, s58, v17 op_sel:[1,0,0] op_sel_hi:[1,0,0]
    v_fma_mix_f32 v10, v79, s58, v10 op_sel:[0,0,0] op_sel_hi:[1,0,0]
    v_fma_mix_f32 v18, v79, s58, v18 op_sel:[0,0,0] op_sel_hi:[1,0,0]
    v_fma_mix_f32 v11, v79, s58, v11 op_sel:[1,0,0] op_sel_hi:[1,0,0]
    v_fma_mix_f32 v19, v79, s58, v19 op_sel:[1,0,0] op_sel_hi:[1,0,0]
    v_readfirstlane_b32 s63, v81
    s_bfe_u32 s63, s63, 0xb0001
    s_sub_u32 s63, 2047, s63
    s_mul_i32 s43, s63, s41
    s_and_b32 s43, s43, 2047
    v_cvt_f32_u32 v81, s43
    v_mul_f32 v81, 0x3a000000, v81
    v_cos_f32 v82, v81
    v_sin_f32 v83, v81
    v_readfirstlane_b32 s70, v82
    v_readfirstlane_b32 s71, v83
    s_mov_b32 s84, 1
    s_and_b32 s43, s63, 255
    s_lshr_b32 s44, s63, 8
    s_cmp_eq_u32 s43, s2
    s_cselect_b32 s44, s44, 99
    s_sub_u32 s46, 2048, s63
    s_and_b32 s46, s46, 2047
    s_and_b32 s43, s46, 255
    s_lshr_b32 s45, s46, 8
    s_cmp_eq_u32 s43, s2
    s_cselect_b32 s45, s45, 99
    s_mov_b32 s72, 7
    s_cmp_eq_u32 s44, 7
    s_cselect_b32 s43, 1, 0
    s_cmp_eq_u32 s45, 7
    s_cselect_b32 s43, 1, s43
    s_cmp_eq_u32 s72, 7
    s_cselect_b32 s43, s43, 0
    s_sub_u32 s72, s72, s43
    s_cmp_eq_u32 s44, 6
    s_cselect_b32 s43, 1, 0
    s_cmp_eq_u32 s45, 6
    s_cselect_b32 s43, 1, s43
    s_cmp_eq_u32 s72, 6
    s_cselect_b32 s43, s43, 0
    s_sub_u32 s72, s72, s43
    s_cmp_lg_u32 s41, s63
    s_cbranch_scc1 L_own_44
    s_and_b32 s43, s2, 7
    s_mul_i32 s43, s43, 4352
    s_add_u32 s43, s43, 1147904
    v_lshlrev_b32_e64 v88, 3, v2
    v_lshl_add_u32 v88, v3, 10, v88
    s_mov_b32 s47, 524288
L_poll_45:
    buffer_load_dword v80, v88, s[12:15], s43 offen offset:0 sc1
    buffer_load_dword v81, v88, s[12:15], s43 offen offset:128 sc1
    buffer_load_dword v82, v88, s[12:15], s43 offen offset:256 sc1
    buffer_load_dword v83, v88, s[12:15], s43 offen offset:384 sc1
    buffer_load_dword v84, v88, s[12:15], s43 offen offset:512 sc1
    buffer_load_dword v85, v88, s[12:15], s43 offen offset:640 sc1
    buffer_load_dword v86, v88, s[12:15], s43 offen offset:768 sc1
    buffer_load_dword v87, v88, s[12:15], s43 offen offset:896 sc1
    s_waitcnt vmcnt(0)
    v_max3_u32 v126, v80, v81, v82
    v_max3_u32 v126, v126, v83, v84
    v_max3_u32 v126, v126, v85, v86
    v_max_u32 v126, v126, v87
    v_cmp_eq_u32 vcc, -1, v126
    s_cbranch_vccz L_pdone_46
    s_mov_b64 exec, vcc
    s_sub_u32 s47, s47, 1
    s_cmp_lg_u32 s47, 0
    s_cbranch_scc1 L_poll_45
    v_mov_b32 v124, 22
    v_mov_b32 v123, 60
    buffer_store_dword v124, v123, s[20:23], 0 offen
L_pdone_46:
    s_mov_b64 exec, -1
    v_add_f32 v4, v4, v80
    v_add_f32 v5, v5, v81
    v_add_f32 v6, v6, v82
    v_add_f32 v7, v7, v83
    v_add_f32 v8, v8, v84
    v_add_f32 v9, v9, v85
    v_add_f32 v10, v10, v86
    v_add_f32 v11, v11, v87
L_own_44:
    s_cmp_lg_u32 s42, s63
    s_cbranch_scc1 L_own_47
    s_and_b32 s43, s2, 7
    s_mul_i32 s43, s43, 4352
    s_add_u32 s43, s43, 1147904
    v_sub_u32 v89, 16, v2
    v_lshlrev_b32 v89, 3, v89
    v_sub_u32_e64 v90, 3, v3
    v_lshl_add_u32 v89, v90, 10, v89
    v_add_u32 v90, 896, v89
    v_and_b32 v90, 4095, v90
    s_mov_b32 s47, 524288
L_poll_48:
    buffer_load_dword v80, v90, s[12:15], s43 offen sc1
    buffer_load_dword v81, v89, s[12:15], s43 offen offset:768 sc1
    buffer_load_dword v82, v89, s[12:15], s43 offen offset:640 sc1
    buffer_load_dword v83, v89, s[12:15], s43 offen offset:512 sc1
    buffer_load_dword v84, v89, s[12:15], s43 offen offset:384 sc1
    buffer_load_dword v85, v89, s[12:15], s43 offen offset:256 sc1
    buffer_load_dword v86, v89, s[12:15], s43 offen offset:128 sc1
    buffer_load_dword v87, v89, s[12:15], s43 offen offset:0 sc1
    s_waitcnt vmcnt(0)
    v_max3_u32 v126, v80, v81, v82
    v_max3_u32 v126, v126, v83, v84
    v_max3_u32 v126, v126, v85, v86
    v_max_u32 v126, v126, v87
    v_cmp_eq_u32 vcc, -1, v126
    s_cbranch_vccz L_pdone_49
    s_mov_b64 exec, vcc
    s_sub_u32 s47, s47, 1
    s_cmp_lg_u32 s47, 0
    s_cbranch_scc1 L_poll_48
    v_mov_b32 v124, 22
    v_mov_b32 v123, 60
    buffer_store_dword v124, v123, s[20:23], 0 offen
L_pdone_49:
    s_mov_b64 exec, -1
    v_add_f32 v12, v12, v80
    v_add_f32 v13, v13, v81
    v_add_f32 v14, v14, v82
    v_add_f32 v15, v15, v83
    v_add_f32 v16, v16, v84
    v_add_f32 v17, v17, v85
    v_add_f32 v18, v18, v86
    v_add_f32 v19, v19, v87
L_own_47:
    s_cmp_lg_u32 s40, s72
    s_cbranch_scc1 L_dl_50
    s_and_b32 s43, s2, 7
    s_mul_i32 s43, s43, 4352
    s_add_u32 s43, s43, 1147904
    v_lshlrev_b32_e64 v120, 3, v2
    v_lshl_add_u32 v120, v3, 10, v120
    v_lshrrev_b32 v76, 1, v3
    v_lshlrev_b32 v76, 7, v76
    v_lshlrev_b32 v77, 3, v2
    v_lshl_add_u32 v77, v3, 9, v77
    v_add_u32 v78, v76, v77
    v_sub_u32 v121, 47360, v78
    v_add_u32 v78, 43264, v78
    s_mov_b32 s47, 524288
L_poll_51:
    buffer_load_dwordx2 v[88:89], v120, s[12:15], s43 offen offset:0 sc1
    buffer_load_dwordx2 v[90:91], v120, s[12:15], s43 offen offset:128 sc1
    buffer_load_dwordx2 v[92:93], v120, s[12:15], s43 offen offset:256 sc1
    buffer_load_dwordx2 v[94:95], v120, s[12:15], s43 offen offset:384 sc1
    buffer_load_dwordx2 v[96:97], v120, s[12:15], s43 offen offset:512 sc1
    buffer_load_dwordx2 v[98:99], v120, s[12:15], s43 offen offset:640 sc1
    buffer_load_dwordx2 v[100:101], v120, s[12:15], s43 offen offset:768 sc1
    buffer_load_dwordx2 v[102:103], v120, s[12:15], s43 offen offset:896 sc1
    s_waitcnt vmcnt(0)
    v_max3_u32 v126, v88, v89, v90
    s_nop 0
    v_max3_u32 v126, v126, v91, v92
    v_max3_u32 v126, v126, v93, v94
    v_max3_u32 v126, v126, v95, v96
    v_max3_u32 v126, v126, v97, v98
    v_max3_u32 v126, v126, v99, v100
    v_max3_u32 v126, v126, v101, v102
    v_max_u32 v126, v126, v103
    v_cmp_eq_u32 vcc, -1, v126
    s_cbranch_vccz L_pdone_52
    s_mov_b64 exec, vcc
    s_sub_u32 s47, s47, 1
    s_cmp_lg_u32 s47, 0
    s_cbranch_scc1 L_poll_51
    v_mov_b32 v124, 7
    v_mov_b32 v123, 60
    buffer_store_dword v124, v123, s[20:23], 0 offen
L_pdone_52:
    s_mov_b64 exec, -1
    v_mov_b32 v120, v78
    v_add_f32 v76, v88, v89
    v_add_f32 v77, v90, v91
    v_add_f32 v78, v92, v93
    v_add_f32 v79, v94, v95
    v_add_f32 v80, v96, v97
    v_add_f32 v81, v98, v99
    v_add_f32 v82, v100, v101
    v_add_f32 v83, v102, v103
    v_add_f32 v84, v89, v91
    v_mul_f32 v86, v89, v89
    v_add_f32 v85, v76, v77
    v_mul_f32 v87, v76, v76
    v_fmac_f32 v86, v91, v91
    v_fmac_f32 v87, v77, v77
    v_add_f32 v84, v84, v93
    v_fmac_f32 v86, v93, v93
    v_add_f32 v85, v85, v78
    v_fmac_f32 v87, v78, v78
    v_add_f32 v84, v84, v95
    v_fmac_f32 v86, v95, v95
    v_add_f32 v85, v85, v79
    v_fmac_f32 v87, v79, v79
    v_add_f32 v84, v84, v97
    v_fmac_f32 v86, v97, v97
    v_add_f32 v85, v85, v80
    v_fmac_f32 v87, v80, v80
    v_add_f32 v84, v84, v99
    v_fmac_f32 v86, v99, v99
    v_add_f32 v85, v85, v81
    v_fmac_f32 v87, v81, v81
    v_add_f32 v84, v84, v101
    v_fmac_f32 v86, v101, v101
    v_add_f32 v85, v85, v82
    v_fmac_f32 v87, v82, v82
    v_add_f32 v84, v84, v103
    v_fmac_f32 v86, v103, v103
    v_add_f32 v85, v85, v83
    v_fmac_f32 v87, v83, v83
    s_nop 0
    v_permlane32_swap_b32 v84, v85
    v_permlane32_swap_b32 v86, v87
    v_add_f32 v84, v84, v85
    v_add_f32 v86, v86, v87
    s_nop 1
    v_permlane16_swap_b32 v84, v86
    v_add_f32 v84, v84, v86
    s_nop 1
    v_add_f32_dpp v84, v84, v84 row_ror:8 row_mask:0xf bank_mask:0xf
    s_nop 1
    v_add_f32_dpp v84, v84, v84 row_ror:4 row_mask:0xf bank_mask:0xf
    s_nop 1
    v_add_f32_dpp v84, v84, v84 row_ror:2 row_mask:0xf bank_mask:0xf
    s_nop 1
    v_add_f32_dpp v84, v84, v84 row_ror:1 row_mask:0xf bank_mask:0xf
    v_mov_b32 v90, v84
    s_nop 1
    v_permlane16_swap_b32 v84, v90
    v_mul_f32 v88, 0x3b000000, v84
    v_mul_f32 v90, 0x3b000000, v90
    v_fma_f32 v90, -v88, v88, v90
    v_max_f32_e64 v90, 0, v90
    v_add_f32 v92, 0x3727c5ac, v90
    v_rsq_f32 v92, v92
    s_nop 0
    v_mul_f32 v96, v88, v92
    v_mov_b32 v94, v92
    s_nop 1
    v_permlane32_swap_b32 v92, v94
    v_mov_b32 v98, v96
    s_nop 1
    v_permlane32_swap_b32 v96, v98
    v_sub_f32 v96, v98, v96
    v_fma_f32 v76, v76, v94, -v96
    v_fma_f32 v77, v77, v94, -v96
    v_fma_f32 v78, v78, v94, -v96
    v_fma_f32 v79, v79, v94, -v96
    v_fma_f32 v80, v80, v94, -v96
    v_fma_f32 v81, v81, v94, -v96
    v_fma_f32 v82, v82, v94, -v96
    v_fma_f32 v83, v83, v94, -v96
    v_fma_f32 v76, -v89, v92, v76
    v_fma_f32 v77, -v91, v92, v77
    v_fma_f32 v78, -v93, v92, v78
    v_fma_f32 v79, -v95, v92, v79
    v_fma_f32 v80, -v97, v92, v80
    v_fma_f32 v81, -v99, v92, v81
    v_fma_f32 v82, -v101, v92, v82
    v_fma_f32 v83, -v103, v92, v83
    v_cvt_pk_f16_f32 v84, v76, v77
    v_cvt_pk_f16_f32 v85, v78, v79
    v_cvt_pk_f16_f32 v86, v80, v81
    v_cvt_pk_f16_f32 v87, v82, v83
    s_nop 1
    v_mfma_f32_16x16x32_f16 v[88:91], v[84:87], v[20:23], 0
    v_mfma_f32_16x16x32_f16 v[92:95], v[84:87], v[24:27], 0
    v_mfma_f32_16x16x32_f16 v[96:99], v[84:87], v[28:31], 0
    v_mfma_f32_16x16x32_f16 v[100:103], v[84:87], v[32:35], 0
    s_nop 4
    v_pk_mul_f32 v[76:77], v[88:89], v[36:37]
    v_pk_mul_f32 v[80:81], v[92:93], v[36:37]
    v_pk_mul_f32 v[78:79], v[90:91], v[38:39]
    v_pk_mul_f32 v[82:83], v[94:95], v[38:39]
    v_pk_fma_f32 v[76:77], v[92:93], v[40:41], v[76:77]
    v_pk_fma_f32 v[80:81], v[88:89], v[40:41], v[80:81] neg_lo:[1,0,0] neg_hi:[1,0,0]
    v_pk_fma_f32 v[78:79], v[94:95], v[42:43], v[78:79]
    v_pk_fma_f32 v[82:83], v[90:91], v[42:43], v[82:83] neg_lo:[1,0,0] neg_hi:[1,0,0]
    v_cvt_pk_f16_f32 v84, v76, v80
    v_cvt_pk_f16_f32 v85, v77, v81
    v_cvt_pk_f16_f32 v86, v78, v82
    v_cvt_pk_f16_f32 v87, v79, v83
    s_nop 1
    v_mfma_f32_16x16x32_f16 v[88:91], v[52:55], v[84:87], 0
    s_nop 0
    v_mfma_f32_16x16x32_f16 v[92:95], v[72:75], v[84:87], 0
    v_pk_mul_f32 v[76:77], v[96:97], v[44:45]
    v_pk_mul_f32 v[80:81], v[100:101], v[44:45]
    v_pk_mul_f32 v[78:79], v[98:99], v[46:47]
    v_pk_mul_f32 v[82:83], v[102:103], v[46:47]
    v_pk_fma_f32 v[76:77], v[100:101], v[48:49], v[76:77]
    v_pk_fma_f32 v[80:81], v[96:97], v[48:49], v[80:81] neg_lo:[1,0,0] neg_hi:[1,0,0]
    v_pk_fma_f32 v[78:79], v[102:103], v[50:51], v[78:79]
    v_pk_fma_f32 v[82:83], v[98:99], v[50:51], v[82:83] neg_lo:[1,0,0] neg_hi:[1,0,0]
    v_cvt_pk_f16_f32 v84, v76, v80
    v_cvt_pk_f16_f32 v85, v77, v81
    v_cvt_pk_f16_f32 v86, v78, v82
    v_cvt_pk_f16_f32 v87, v79, v83
    s_nop 1
    v_mfma_f32_16x16x32_f16 v[96:99], v[52:55], v[84:87], 0
    ds_write_b64 v120, v[88:89] offset:0
    ds_write_b64 v120, v[90:91] offset:256
    s_nop 5
    ds_write_b64 v120, v[96:97] offset:128
    ds_write_b64 v120, v[98:99] offset:384
    v_mov_b32_e64 v93, 0
    v_mov_b32 v76, 45568
    v_xor_b32 v89, 0x80000000, v89
    v_xor_b32 v91, 0x80000000, v91
    v_xor_b32 v97, 0x80000000, v97
    v_xor_b32 v99, 0x80000000, v99
    ds_write_b64 v121, v[88:89] offset:384
    ds_write_b64 v121, v[90:91] offset:128
    ds_write_b64 v121, v[96:97] offset:256
    ds_write_b64 v121, v[98:99] offset:0
    s_mov_b64 exec, 1
    ds_write_b64 v76, v[92:93]
    s_mov_b32 exec_lo, 0
    s_mov_b32 exec_hi, 1
    ds_write_b64 v121, v[88:89] offset:512
    s_mov_b64 exec, -1
    v_mov_b32 v120, 6404
L_dl_50:
    v_mov_b32 v76, s70
    v_mov_b32 v77, s71
    v_mul_u32_u24 v96, 1152, v3
    v_lshl_add_u32 v96, v2, 3, v96
    v_add_u32 v96, 43264, v96
    s_waitcnt lgkmcnt(0)
    s_barrier
    ds_read_b64 v[80:81], v96 offset:0
    ds_read_b64 v[82:83], v96 offset:128
    ds_read_b64 v[84:85], v96 offset:256
    ds_read_b64 v[86:87], v96 offset:384
    ds_read_b64 v[88:89], v96 offset:512
    ds_read_b64 v[90:91], v96 offset:640
    ds_read_b64 v[92:93], v96 offset:768
    ds_read_b64 v[94:95], v96 offset:896
    s_waitcnt lgkmcnt(4)
    v_mul_f32 v80, v76, v80
    v_mul_f32 v82, v76, v82
    v_mul_f32 v84, v76, v84
    v_mul_f32 v86, v76, v86
    v_fmac_f32 v80, v77, v81
    v_fmac_f32 v82, v77, v83
    v_fmac_f32 v84, v77, v85
    v_fmac_f32 v86, v77, v87
    s_waitcnt lgkmcnt(0)
    v_mul_f32 v88, v76, v88
    v_mul_f32 v90, v76, v90
    v_mul_f32 v92, v76, v92
    v_mul_f32 v94, v76, v94
    v_fmac_f32 v88, v77, v89
    v_fmac_f32 v90, v77, v91
    v_fmac_f32 v92, v77, v93
    v_fmac_f32 v94, v77, v95
    v_add_f32 v4, v4, v80
    v_add_f32 v12, v12, v80
    v_add_f32 v5, v5, v82
    v_add_f32 v13, v13, v82
    v_add_f32 v6, v6, v84
    v_add_f32 v14, v14, v84
    v_add_f32 v7, v7, v86
    v_add_f32 v15, v15, v86
    v_add_f32 v8, v8, v88
    v_add_f32 v16, v16, v88
    v_add_f32 v9, v9, v90
    v_add_f32 v17, v17, v90
    v_add_f32 v10, v10, v92
    v_add_f32 v18, v18, v92
    v_add_f32 v11, v11, v94
    v_add_f32_e64 v19, v19, v94
    s_branch L_stats
L_k5_cont:
    v_fma_f32 v4, v4, v93, -v94
    v_fma_f32 v5, v5, v93, -v94
    v_fma_f32 v6, v6, v93, -v94
    v_fma_f32 v7, v7, v93, -v94
    v_fma_f32 v8, v8, v93, -v94
    v_fma_f32 v9, v9, v93, -v94
    v_fma_f32 v10, v10, v93, -v94
    v_fma_f32 v11, v11, v93, -v94
    v_fma_f32 v12, v12, v95, -v96
    v_fma_f32 v13, v13, v95, -v96
    v_fma_f32 v14, v14, v95, -v96
    v_fma_f32 v15, v15, v95, -v96
    v_fma_f32 v16, v16, v95, -v96
    v_fma_f32 v17, v17, v95, -v96
    v_fma_f32 v18, v18, v95, -v96
    v_fma_f32 v19, v19, v95, -v96
    s_mul_i32 s43, s40, 2304
    s_add_u32 s43, s43, 17152
    s_add_u32 s44, s43, 1152
    v_lshlrev_b32 v87, 4, v1
    v_lshl_add_u32 v87, v3, 5, v87
    v_add_u32 v87, s43, v87
    v_mul_u32_u24 v90, 288, v3
    v_lshl_add_u32 v84, v2, 1, v90
    v_add_u32 v84, s43, v84
    v_sub_u32 v90, 3, v3
    v_mul_u32_u24 v90, 288, v90
    v_sub_u32 v91, 16, v2
    v_lshl_add_u32 v85, v91, 1, v90
    v_add_u32 v85, s44, v85
    v_sub_u32 v90, 4, v3
    v_and_b32 v90, 3, v90
    v_mul_u32_u24 v90, 288, v90
    v_add_u32 v90, s44, v90
    v_add_u32 v86, 224, v85
    v_cmp_eq_u32 vcc, 0, v2
    s_nop 1
    v_cndmask_b32 v86, v86, v90, vcc
    v_cvt_pk_bf16_f32 v92, v4, v5
    v_cvt_pk_bf16_f32 v96, v12, v13
    v_cvt_pk_bf16_f32 v93, v6, v7
    v_cvt_pk_bf16_f32 v97, v14, v15
    v_cvt_pk_bf16_f32 v94, v8, v9
    v_cvt_pk_bf16_f32 v98, v16, v17
    v_cvt_pk_bf16_f32 v95, v10, v11
    v_cvt_pk_bf16_f32 v99, v18, v19
    ds_write_b16 v84, v92 offset:0
    ds_write_b16_d16_hi v84, v92 offset:32
    ds_write_b16 v84, v93 offset:64
    ds_write_b16_d16_hi v84, v93 offset:96
    ds_write_b16 v84, v94 offset:128
    ds_write_b16_d16_hi v84, v94 offset:160
    ds_write_b16 v84, v95 offset:192
    ds_write_b16_d16_hi v84, v95 offset:224
    ds_write_b16 v86, v96
    ds_write_b16_d16_hi v85, v96 offset:192
    ds_write_b16 v85, v97 offset:160
    ds_write_b16_d16_hi v85, v97 offset:128
    ds_write_b16 v85, v98 offset:96
    ds_write_b16_d16_hi v85, v98 offset:64
    ds_write_b16 v85, v99 offset:32
    ds_write_b16_d16_hi v85, v99 offset:0
    s_waitcnt lgkmcnt(0)
    ds_read_b128 v[100:103], v87
    ds_read_b128 v[104:107], v87 offset:1152
    v_lshlrev_b32 v108, 4, v1
    s_bfe_u32 s64, s59, 0xb0001
    s_sub_u32 s64, 2047, s64
    s_and_b32 s65, s59, 1
    s_xor_b32 s65, s65, 1
    s_mov_b32 s72, s64
    s_lshl_b32 s70, s41, 10
    s_lshl_b32 s71, s42, 10
    s_waitcnt lgkmcnt(0)
    s_cmp_eq_u32 s41, s72
    s_cbranch_scc1 L_st_53
    buffer_store_dwordx4 v[100:103], v108, s[16:19], s70 offen sc1
L_st_53:
    s_cmp_eq_u32 s42, s72
    s_cbranch_scc1 L_st_54
    buffer_store_dwordx4 v[104:107], v108, s[16:19], s71 offen sc1
L_st_54:
    s_cmp_eq_u32 s41, s72
    s_cbranch_scc1 L_fing_56
    s_cmp_lg_u32 s42, s72
    s_cbranch_scc1 L_fin_55
L_fing_56:
    s_and_b32 s43, s2, 15
    s_lshl_b32 s43, s43, 8
    s_add_u32 s43, s43, 1182720
    v_mov_b32_e64 v76, 0
    s_mov_b32 s47, 524288
L_poll_57:
    buffer_load_dword v77, v76, s[12:15], s43 offen sc1
    s_waitcnt vmcnt(0)
    v_cmp_eq_u32 vcc, -1, v77
    s_cbranch_vccz L_pdone_58
    s_mov_b64 exec, vcc
    s_sub_u32 s47, s47, 1
    s_cmp_lg_u32 s47, 0
    s_cbranch_scc1 L_poll_57
    v_mov_b32 v124, 10
    v_mov_b32 v123, 60
    buffer_store_dword v124, v123, s[20:23], 0 offen
L_pdone_58:
    s_mov_b64 exec, -1
    v_readfirstlane_b32 s61, v77
    s_bfe_u32 s64, s61, 0xb0001
    s_sub_u32 s64, 2047, s64
    s_and_b32 s65, s61, 1
    s_xor_b32 s65, s65, 1
    s_cmp_eq_u32 s64, s72
    s_cbranch_scc1 L_fin_55
    s_cmp_lg_u32 s41, s72
    s_cbranch_scc1 L_st2_59
    buffer_store_dwordx4 v[100:103], v108, s[16:19], s70 offen sc1
L_st2_59:
    s_cmp_lg_u32 s42, s72
    s_cbranch_scc1 L_st2_60
    buffer_store_dwordx4 v[104:107], v108, s[16:19], s71 offen sc1
L_st2_60:
L_fin_55:
    s_branch L_end
L_ffn:
    s_sub_u32 s54, s2, 129
    s_cmp_ge_u32 s54, 74
    s_cbranch_scc1 L_nxa_62
    v_lshlrev_b32 v76, 4, v0
    v_mov_b32 v80, -1
    v_mov_b32 v81, -1
    v_mov_b32 v82, -1
    v_mov_b32 v83, -1
    s_mov_b32 s72, s12
    s_mov_b32 s73, s13
    s_mov_b32 s74, 1190912
    s_mov_b32 s75, 0x00020000
    s_mul_i32 s43, s54, 16384
    v_add_u32_e64 v79, s43, v76
    buffer_store_dwordx4 v[80:83], v79, s[72:75], 0 offen sc1
    s_add_u32 s43, s43, 8192
    v_add_u32 v79, s43, v76
    buffer_store_dwordx4 v[80:83], v79, s[72:75], 0 offen sc1
    s_waitcnt vmcnt(0)
    s_barrier
    s_cmp_lg_u32 s40, 0
    s_cbranch_scc1 L_b0_63
    s_and_b32 s44, s54, 1
    s_lshl_b32 s44, s44, 6
    v_mov_b32 v78, s44
    v_mov_b32 v77, 1
    s_mov_b64 exec, 1
    buffer_atomic_add v77, v78, s[20:23], 0 offen sc0 sc1
    s_waitcnt vmcnt(0)
    v_readfirstlane_b32 s43, v77
    s_cmp_lg_u32 s43, 36
    s_cbranch_scc1 L_b0l_64
    v_mov_b32 v77, 1
    buffer_store_dword v77, v78, s[20:23], 0 offen offset:128 sc1
L_b0l_64:
    s_mov_b64 exec, -1
L_b0_63:
L_nxa_62:
    s_cmp_ge_u32 s54, 68
    s_cbranch_scc1 L_nxb_61
    v_lshlrev_b32 v76, 4, v0
    v_mov_b32 v80, -1
    v_mov_b32 v81, -1
    v_mov_b32 v82, -1
    v_mov_b32 v83, -1
    s_mov_b32 s72, s12
    s_mov_b32 s73, s13
    s_mov_b32 s74, 3506176
    s_mov_b32 s75, 0x00020000
    s_mul_i32 s43, s54, 32768
    s_add_u32 s43, s43, 1277952
    v_add_u32_e64 v79, s43, v76
    buffer_store_dwordx4 v[80:83], v79, s[72:75], 0 offen sc1
    s_add_u32 s43, s43, 8192
    v_add_u32_e64 v79, s43, v76
    buffer_store_dwordx4 v[80:83], v79, s[72:75], 0 offen sc1
    s_add_u32 s43, s43, 8192
    v_add_u32_e64 v79, s43, v76
    buffer_store_dwordx4 v[80:83], v79, s[72:75], 0 offen sc1
    s_add_u32 s43, s43, 8192
    v_add_u32 v79, s43, v76
    buffer_store_dwordx4 v[80:83], v79, s[72:75], 0 offen sc1
    s_waitcnt vmcnt(0)
    s_barrier
    s_cmp_lg_u32 s40, 0
    s_cbranch_scc1 L_b0_65
    s_and_b32 s44, s54, 1
    s_lshl_b32 s44, s44, 6
    s_add_u32 s44, s44, 8
    v_mov_b32 v78, s44
    v_mov_b32 v77, 1
    s_mov_b64 exec, 1
    buffer_atomic_add v77, v78, s[20:23], 0 offen sc0 sc1
    s_waitcnt vmcnt(0)
    v_readfirstlane_b32 s43, v77
    s_cmp_lg_u32 s43, 33
    s_cbranch_scc1 L_b0l_66
    v_mov_b32 v77, 1
    buffer_store_dword v77, v78, s[20:23], 0 offen offset:128 sc1
L_b0l_66:
    s_mov_b64 exec, -1
L_b0_65:
L_nxb_61:
    s_cmp_ge_u32 s2, 247
    s_cbranch_scc1 L_end
    s_cmp_lt_u32 s2, 215
    s_cbranch_scc1 L_rolea_67
    s_sub_u32 s43, s2, 215
    s_and_b32 s44, s43, 7
    s_lshl_b32 s44, s44, 2
    s_lshr_b32 s43, s43, 3
    s_add_u32 s54, s43, s44
    s_lshl_b32 s55, s54, 4
    v_lshrrev_b32 v76, 1, v0
    v_lshlrev_b32 v76, 10, v76
    v_and_b32 v77, 1, v0
    v_lshl_add_u32 v76, v77, 4, v76
    s_lshl_b32 s43, s54, 5
    buffer_load_dwordx4 v[80:83], v76, s[36:39], s43 offen
    s_add_u32 s43, s43, 262144
    buffer_load_dwordx4 v[84:87], v76, s[36:39], s43 offen
    s_add_u32 s43, s43, 262144
    buffer_load_dwordx4 v[88:91], v76, s[36:39], s43 offen
    s_add_u32 s43, s43, 262144
    buffer_load_dwordx4 v[92:95], v76, s[36:39], s43 offen
    s_add_u32 s43, s43, 262144
    buffer_load_dwordx4 v[96:99], v76, s[36:39], s43 offen
    s_add_u32 s43, s43, 262144
    buffer_load_dwordx4 v[100:103], v76, s[36:39], s43 offen
    v_lshlrev_b32 v77, 4, v0
    v_mov_b32 v104, 0
    v_lshlrev_b32 v105, 2, v0
    ds_write_b32 v105, v104 offset:49152
    s_cmp_gt_u32 s40, 3
    s_cbranch_scc1 L_hz_68
    ds_write_b32 v105, v104 offset:51200
L_hz_68:
    s_waitcnt vmcnt(5)
    ds_write_b128 v77, v[80:83] offset:0
    s_waitcnt vmcnt(4)
    ds_write_b128 v77, v[84:87] offset:8192
    s_waitcnt vmcnt(3)
    ds_write_b128 v77, v[88:91] offset:16384
    s_waitcnt vmcnt(2)
    ds_write_b128 v77, v[92:95] offset:24576
    s_waitcnt vmcnt(1)
    ds_write_b128 v77, v[96:99] offset:32768
    s_waitcnt vmcnt(0)
    ds_write_b128 v77, v[100:103] offset:40960
    s_waitcnt lgkmcnt(0)
    s_barrier
    s_lshl_b32 s43, s40, 5
    v_lshrrev_b32 v76, 2, v2
    v_lshl_add_u32 v76, v3, 3, v76
    v_add_u32 v76, s43, v76
    v_lshlrev_b32 v76, 5, v76
    v_and_b32 v122, 3, v2
    v_lshl_add_u32 v76, v122, 3, v76
    ds_read_b64_tr_b16 v[20:21], v76 offset:0
    ds_read_b64_tr_b16 v[22:23], v76 offset:128
    ds_read_b64_tr_b16 v[24:25], v76 offset:8192
    ds_read_b64_tr_b16 v[26:27], v76 offset:8320
    ds_read_b64_tr_b16 v[28:29], v76 offset:16384
    ds_read_b64_tr_b16 v[30:31], v76 offset:16512
    ds_read_b64_tr_b16 v[32:33], v76 offset:24576
    ds_read_b64_tr_b16 v[34:35], v76 offset:24704
    ds_read_b64_tr_b16 v[36:37], v76 offset:32768
    ds_read_b64_tr_b16 v[38:39], v76 offset:32896
    ds_read_b64_tr_b16 v[40:41], v76 offset:40960
    ds_read_b64_tr_b16 v[42:43], v76 offset:41088
    v_lshlrev_b32 v48, 2, v2
    v_mov_b32 v49, 52736
    v_lshlrev_b32 v51, 1, v2
    v_mul_u32_u24 v50, 4352, v3
    v_lshl_add_u32 v50, v2, 3, v50
    s_lshl_b32 s43, s40, 6
    s_add_u32 s43, s43, 49152
    v_lshlrev_b32 v44, 4, v3
    v_add_u32 v44, s43, v44
    s_lshl_b32 s43, s40, 6
    s_add_u32 s43, s43, 52224
    v_lshlrev_b32 v45, 2, v2
    v_add_u32 v45, s43, v45
    v_min_u32 v46, 171, v0
    v_lshlrev_b32 v47, 4, v46
    v_add_u32 v47, 49152, v47
    v_and_b32 v77, 1, v46
    v_lshrrev_b32 v46, 1, v46
    v_lshlrev_b32 v46, 6, v46
    v_lshl_add_u32 v46, v77, 4, v46
    s_and_b32 s43, s2, 1
    s_mul_i32 s43, s43, 5632
    v_add_u32 v46, s43, v46
    s_waitcnt lgkmcnt(0)
    s_cmp_lg_u32 s40, 0
    s_cbranch_scc1 L_fb0_69
    s_mov_b32 s47, 524288
    v_and_b32 v126, 1, v1
    v_lshlrev_b32_e64 v126, 6, v126
    v_add_u32 v126, 128, v126
L_pc_70:
    buffer_load_dword v127, v126, s[20:23], 0 offen sc1
    s_waitcnt vmcnt(0)
    v_cmp_eq_u32_e64 vcc, 0, v127
    s_cbranch_vccz L_pcd_71
    s_sub_u32 s47, s47, 1
    s_cmp_lg_u32 s47, 0
    s_cbranch_scc1 L_pc_70
    v_mov_b32 v124, 11
    v_mov_b32 v123, 60
    buffer_store_dword v124, v123, s[20:23], 0 offen
L_pcd_71:
L_fb0_69:
    s_barrier
    s_mov_b32 s76, 1090560
    s_mov_b32 s77, 4620288
    s_mov_b32 s78, 1125376
    s_mov_b32 s79, 1186816
    s_mov_b32 s83, 0
L_fb_loop:
    s_cmp_lg_u32 s40, 7
    s_cbranch_scc1 L_ba_72
    s_and_b32 s43, s2, 15
    s_lshl_b32 s43, s43, 8
    s_add_u32 s43, s43, s79
    v_mov_b32_e64 v76, 0
    s_mov_b32 s47, 524288
L_ps_73:
    buffer_load_dword v77, v76, s[12:15], s43 offen sc1
    s_waitcnt vmcnt(0)
    v_cmp_eq_u32_e64 vcc, -1, v77
    s_cbranch_vccz L_psd_74
    s_sub_u32 s47, s47, 1
    s_cmp_lg_u32 s47, 0
    s_cbranch_scc1 L_ps_73
    v_mov_b32 v124, 16
    v_mov_b32 v123, 60
    buffer_store_dword v124, v123, s[20:23], 0 offen
L_psd_74:
    v_readfirstlane_b32 s61, v77
    s_bfe_u32 s64, s61, 0xb0001
    s_sub_u32 s64, 2047, s64
    s_and_b32 s65, s61, 1
    s_xor_b32 s65, s65, 1
L_ba_72:
    s_barrier
    s_cmp_lg_u32 s40, 7
    s_cbranch_scc1 L_ba2_75
    s_cmp_lg_u32 s2, 9999
    s_cbranch_scc1 L_k2_76
    v_mov_b32 v82, s61
    v_lshlrev_b32 v83, 8, v1
    s_mov_b32 s43, s79
    s_mov_b64 exec, 0xffff
    buffer_store_dword v82, v83, s[12:15], s43 offen sc1
    s_mov_b64 exec, -1
L_k2_76:
    s_and_b32 s45, s64, 255
    s_sub_u32 s46, 256, s45
    s_min_u32 s45, s45, s46
    s_mul_i32 s45, s45, 3328
    s_add_u32 s45, s45, s77
    s_add_u32 s45, s45, 1024
    v_add_u32_e64 v76, s55, v2
    v_sub_u32 v77, 512, v76
    v_and_b32 v77, 511, v77
    s_cmp_eq_u32 s65, 1
    s_cselect_b64 vcc, -1, 0
    v_cndmask_b32 v76, v76, v77, vcc
    v_and_b32 v78, 15, v76
    v_lshrrev_b32 v77, 7, v76
    v_lshl_add_u32 v78, v77, 4, v78
    v_lshlrev_b32 v78, 4, v78
    v_bfe_u32 v77, v76, 6, 1
    v_lshl_add_u32 v78, v77, 10, v78
    v_bfe_u32 v77, v76, 4, 2
    v_lshl_add_u32 v78, v77, 2, v78
    v_mov_b32 v82, 2048
    s_mov_b32 s47, 524288
L_poll_77:
    buffer_load_dword v80, v78, s[12:15], s45 offen sc1
    buffer_load_dword v83, v82, s[12:15], s45 offen sc1
    s_waitcnt vmcnt(0)
    v_max_u32 v126, v80, v83
    v_cmp_eq_u32 vcc, -1, v126
    s_cbranch_vccz L_pdone_78
    s_mov_b64 exec, vcc
    s_sub_u32 s47, s47, 1
    s_cmp_lg_u32 s47, 0
    s_cbranch_scc1 L_poll_77
    v_mov_b32 v124, 18
    v_mov_b32 v123, 60
    buffer_store_dword v124, v123, s[20:23], 0 offen
L_pdone_78:
    s_mov_b64 exec, -1
    v_lshlrev_b32 v81, 2, v2
    v_add_u32 v81, 52800, v81
    ds_write_b32 v81, v80
    v_mul_f32 v87, 0xbfb8aa3b, v83
    v_exp_f32 v87, v87
    s_nop 0
    v_add_f32 v87, 1.0, v87
    v_rcp_f32 v89, v87
    s_lshl_b32 s43, s64, 10
    s_lshl_b32 s44, s55, 1
    s_add_u32 s43, s43, s44
    v_mov_b32 v88, s43
    v_mov_b32 v90, 52736
    ds_write_b64 v90, v[88:89]
L_ba2_75:
    s_cmp_gt_u32 s40, 2
    s_cbranch_scc1 L_bh_79
    s_mov_b32 s43, s78
    s_mov_b32 s47, 524288
L_poll_80:
    buffer_load_dwordx4 v[76:79], v46, s[12:15], s43 offen sc1
    s_waitcnt vmcnt(0)
    v_max3_u32 v126, v76, v77, v78
    v_max_u32 v126, v126, v79
    v_cmp_eq_u32 vcc, -1, v126
    s_cbranch_vccz L_pdone_81
    s_mov_b64 exec, vcc
    s_sub_u32 s47, s47, 1
    s_cmp_lg_u32 s47, 0
    s_cbranch_scc1 L_poll_80
    v_mov_b32 v124, 19
    v_mov_b32 v123, 60
    buffer_store_dword v124, v123, s[20:23], 0 offen
L_pdone_81:
    s_mov_b64 exec, -1
    ds_write_b128 v47, v[76:79]
L_bh_79:
    s_waitcnt lgkmcnt(0)
    s_barrier
    ds_read_b128 v[76:79], v44 offset:0
    ds_read_b128 v[80:83], v44 offset:512
    ds_read_b128 v[84:87], v44 offset:1024
    ds_read_b128 v[88:91], v44 offset:1536
    ds_read_b128 v[92:95], v44 offset:2048
    ds_read_b128 v[96:99], v44 offset:2560
    s_waitcnt lgkmcnt(5)
    v_mfma_f32_16x16x32_bf16 v[100:103], v[76:79], v[20:23], 0
    s_waitcnt lgkmcnt(4)
    v_mfma_f32_16x16x32_bf16 v[104:107], v[80:83], v[24:27], 0
    s_waitcnt lgkmcnt(3)
    v_mfma_f32_16x16x32_bf16 v[100:103], v[84:87], v[28:31], v[100:103]
    s_waitcnt lgkmcnt(2)
    v_mfma_f32_16x16x32_bf16 v[104:107], v[88:91], v[32:35], v[104:107]
    s_waitcnt lgkmcnt(1)
    v_mfma_f32_16x16x32_bf16 v[100:103], v[92:95], v[36:39], v[100:103]
    s_waitcnt lgkmcnt(0)
    v_mfma_f32_16x16x32_bf16 v[104:107], v[96:99], v[40:43], v[104:107]
    s_nop 7
    v_add_f32_e64 v100, v100, v104
    s_mov_b64 exec, 0xffff
    ds_write_b32 v45, v100
    s_mov_b64 exec, -1
    s_waitcnt lgkmcnt(0)
    s_barrier
    s_cmp_lg_u32 s40, 0
    s_cbranch_scc1 L_bf_82
    ds_read_b32 v80, v48 offset:52224
    ds_read_b32 v81, v48 offset:52288
    ds_read_b32 v82, v48 offset:52352
    ds_read_b32 v83, v48 offset:52416
    ds_read_b32 v84, v48 offset:52480
    ds_read_b32 v85, v48 offset:52544
    ds_read_b32 v86, v48 offset:52608
    ds_read_b32 v87, v48 offset:52672
    ds_read_b64 v[88:89], v49
    ds_read_b32 v90, v48 offset:52800
    s_lshl_b32 s43, s55, 3
    s_add_u32 s43, s43, 1147904
    s_waitcnt lgkmcnt(0)
    v_add_f32 v80, v80, v81
    v_add_f32 v82, v82, v83
    v_add_f32 v84, v84, v85
    v_add_f32 v86, v86, v87
    v_add_f32 v80, v80, v82
    v_add_f32 v84, v84, v86
    v_add_f32 v80, v80, v84
    v_mul_f32 v80, v80, v89
    s_cmp_lg_u32 s83, 0
    s_cbranch_scc1 L_bout_83
    v_mov_b32_e64 v81, v90
    buffer_store_dwordx2 v[80:81], v50, s[12:15], s43 offen sc1
    s_add_u32 s43, s43, 17408
    buffer_store_dwordx2 v[80:81], v50, s[12:15], s43 offen sc1
    s_branch L_bend_84
L_bout_83:
    v_add_f32 v80, v80, v90
    s_nop 1
    v_mov_b32_dpp v81, v80 row_shl:1 row_mask:0xf bank_mask:0xf bound_ctrl:1
    v_cvt_pk_bf16_f32 v82, v80, v81
    v_readfirstlane_b32 s43, v88
    s_mov_b64 exec, 0x5555
    s_nop 3
    buffer_store_dword v82, v51, s[16:19], s43 offen sc1
    s_mov_b64 exec, -1
L_bend_84:
L_bf_82:
    s_cmp_lg_u32 s83, 0
    s_cbranch_scc1 L_end
    s_mov_b32 s76, 1107968
    s_mov_b32 s77, 5050368
    s_mov_b32 s78, 1136640
    s_mov_b32 s79, 1182720
    s_mov_b32 s83, 1
    s_branch L_fb_loop
    s_branch L_end
L_rolea_67:
    s_sub_u32 s54, s2, 129
    s_and_b32 s43, s54, 7
    s_lshr_b32 s44, s54, 3
    s_mul_i32 s45, s43, 11
    s_cmp_eq_u32 s43, 7
    s_cselect_b32 s45, 76, s45
    s_add_u32 s54, s44, s45
    v_lshrrev_b32 v76, 1, v0
    v_mul_u32_u24 v76, 2752, v76
    v_and_b32 v77, 1, v0
    v_lshl_add_u32 v76, v77, 4, v76
    s_lshl_b32 s43, s54, 5
    s_add_u32 s44, s43, 704512
    buffer_load_dwordx4 v[80:83], v76, s[28:31], s43 offen
    s_waitcnt vmcnt(0)
    buffer_load_dwordx4 v[84:87], v76, s[28:31], s44 offen
    buffer_load_dwordx4 v[88:91], v76, s[32:35], s43 offen
    buffer_load_dwordx4 v[92:95], v76, s[32:35], s44 offen
    v_lshlrev_b32 v77, 4, v0
    s_waitcnt vmcnt(0)
    ds_write_b128 v77, v[80:83] offset:0
    ds_write_b128 v77, v[84:87] offset:8192
    ds_write_b128 v77, v[88:91] offset:16384
    ds_write_b128 v77, v[92:95] offset:24576
    s_waitcnt lgkmcnt(0)
    s_barrier
    s_lshl_b32 s43, s40, 7
    v_lshrrev_b32 v76, 2, v2
    v_lshl_add_u32 v76, v3, 3, v76
    v_add_u32_e64 v76, s43, v76
    v_lshlrev_b32 v76, 5, v76
    v_and_b32 v122, 3, v2
    v_lshl_add_u32 v76, v122, 3, v76
    ds_read_b64_tr_b16 v[20:21], v76 offset:0
    ds_read_b64_tr_b16 v[22:23], v76 offset:128
    ds_read_b64_tr_b16 v[24:25], v76 offset:1024
    ds_read_b64_tr_b16 v[26:27], v76 offset:1152
    ds_read_b64_tr_b16 v[28:29], v76 offset:2048
    ds_read_b64_tr_b16 v[30:31], v76 offset:2176
    ds_read_b64_tr_b16 v[32:33], v76 offset:3072
    ds_read_b64_tr_b16 v[34:35], v76 offset:3200
    s_and_b32 s43, s40, 3
    s_mul_i32 s43, s43, 288
    s_add_u32 s43, s43, 49152
    v_lshlrev_b32 v36, 4, v3
    v_add_u32 v36, s43, v36
    s_lshl_b32 s43, s40, 6
    s_add_u32 s43, s43, 52224
    v_lshlrev_b32 v37, 2, v2
    v_add_u32 v37, s43, v37
    v_mul_u32_u24 v106, 288, v3
    v_lshl_add_u32 v38, v2, 1, v106
    v_add_u32 v38, 49152, v38
    v_sub_u32 v106, 3, v3
    v_mul_u32_u24 v106, 288, v106
    v_sub_u32 v107, 16, v2
    v_lshl_add_u32 v39, v107, 1, v106
    v_add_u32 v39, 49152, v39
    v_sub_u32 v106, 4, v3
    v_and_b32 v106, 3, v106
    v_mul_u32_u24 v106, 288, v106
    v_add_u32 v106, 49152, v106
    v_add_u32 v40, 224, v39
    v_cmp_eq_u32 vcc, 0, v2
    s_nop 1
    v_cndmask_b32 v40, v40, v106, vcc
    v_lshlrev_b32 v43, 4, v1
    v_lshlrev_b32_e64 v41, 2, v2
    v_mul_u32_u24 v42, 5632, v3
    v_lshl_add_u32 v42, v2, 1, v42
    s_waitcnt lgkmcnt(0)
    s_cmp_lg_u32 s40, 0
    s_cbranch_scc1 L_fb0_85
    s_mov_b32 s47, 524288
    v_and_b32 v126, 1, v1
    v_lshlrev_b32_e64 v126, 6, v126
    v_add_u32 v126, 128, v126
L_pc_86:
    buffer_load_dword v127, v126, s[20:23], 0 offen sc1
    s_waitcnt vmcnt(0)
    v_cmp_eq_u32 vcc, 0, v127
    s_cbranch_vccz L_pcd_87
    s_sub_u32 s47, s47, 1
    s_cmp_lg_u32 s47, 0
    s_cbranch_scc1 L_pc_86
    v_mov_b32_e64 v124, 11
    v_mov_b32 v123, 60
    buffer_store_dword v124, v123, s[20:23], 0 offen
L_pcd_87:
L_fb0_85:
    s_barrier
    s_mov_b32 s76, 1090560
    s_mov_b32 s77, 4620288
    s_mov_b32 s78, 1125376
    s_mov_b32 s79, 1186816
    s_mov_b32 s83, 0
L_fa_loop:
    s_cmp_lg_u32 s40, 0
    s_cbranch_scc1 L_fa_88
    v_lshlrev_b32 v79, 5, v1
    v_mov_b32 v80, 4096
    s_and_b32 s43, s2, 3
    s_mul_i32 s43, s43, 4352
    s_add_u32 s43, s43, s76
    s_add_u32 s44, s43, 2048
    s_mov_b32 s47, 524288
L_gp_89:
    buffer_load_dword v76, v79, s[12:15], s43 offen sc1
    buffer_load_dword v77, v79, s[12:15], s44 offen sc1
    buffer_load_dword v78, v80, s[12:15], s43 offen sc1
    s_waitcnt vmcnt(0)
    v_max3_u32 v81, v76, v77, v78
    v_cmp_eq_u32 vcc, -1, v81
    s_cbranch_vccz L_gpd_90
    s_mov_b64 exec, vcc
    s_sub_u32 s47, s47, 1
    s_cmp_lg_u32 s47, 0
    s_cbranch_scc1 L_gp_89
    v_mov_b32 v124, 12
    v_mov_b32 v123, 60
    buffer_store_dword v124, v123, s[20:23], 0 offen
L_gpd_90:
    s_mov_b64 exec, -1
    v_max_u32_dpp v81, v81, v81 row_shr:1 row_mask:0xf bank_mask:0xf
    s_nop 1
    v_max_u32_dpp v81, v81, v81 row_shr:2 row_mask:0xf bank_mask:0xf
    s_nop 1
    v_max_u32_dpp v81, v81, v81 row_shr:4 row_mask:0xf bank_mask:0xf
    s_nop 1
    v_max_u32_dpp v81, v81, v81 row_shr:8 row_mask:0xf bank_mask:0xf
    s_nop 1
    v_max_u32_dpp v81, v81, v81 row_bcast:15 row_mask:0xa bank_mask:0xf
    s_nop 1
    v_max_u32_dpp v81, v81, v81 row_bcast:31 row_mask:0xc bank_mask:0xf
    s_nop 0
    v_readlane_b32 s61, v81, 63
    s_bfe_u32 s64, s61, 0xb0001
    s_sub_u32 s64, 2047, s64
    s_and_b32 s65, s61, 1
    s_xor_b32 s65, s65, 1
    s_cmp_lg_u32 s54, 0
    s_cbranch_scc1 L_k2a_91
    v_mov_b32 v82, s61
    v_lshlrev_b32 v83, 8, v1
    s_mov_b32 s43, s79
    s_mov_b64 exec, 0xffff
    buffer_store_dword v82, v83, s[12:15], s43 offen sc1
    s_mov_b64 exec, -1
L_k2a_91:
    s_and_b32 s45, s64, 255
    s_sub_u32 s46, 256, s45
    s_min_u32 s45, s45, s46
    s_mul_i32 s45, s45, 3328
    s_add_u32 s45, s45, s77
    s_mov_b32 s47, 524288
L_poll_94:
    buffer_load_dwordx4 v[76:79], v43, s[12:15], s45 offen sc1
    s_waitcnt vmcnt(0)
    v_max3_u32 v126, v76, v77, v78
    v_max_u32 v126, v126, v79
    v_cmp_eq_u32_e64 vcc, -1, v126
    s_cbranch_vccz L_pdone_95
    s_mov_b64 exec, vcc
    s_sub_u32 s47, s47, 1
    s_cmp_lg_u32 s47, 0
    s_cbranch_scc1 L_poll_94
    v_mov_b32 v124, 14
    v_mov_b32 v123, 60
    buffer_store_dword v124, v123, s[20:23], 0 offen
L_pdone_95:
    s_mov_b64 exec, -1
L_rowok_92:
    s_cmp_eq_u32 s65, 1
    s_cbranch_scc1 L_fao_96
    ds_write_b16 v38, v76 offset:0
    ds_write_b16_d16_hi v38, v76 offset:32
    ds_write_b16 v38, v77 offset:64
    ds_write_b16_d16_hi v38, v77 offset:96
    ds_write_b16 v38, v78 offset:128
    ds_write_b16_d16_hi v38, v78 offset:160
    ds_write_b16 v38, v79 offset:192
    ds_write_b16_d16_hi v38, v79 offset:224
    s_branch L_fae_97
L_fao_96:
    ds_write_b16 v40, v76
    s_nop 0
    ds_write_b16_d16_hi v39, v76 offset:192
    ds_write_b16 v39, v77 offset:160
    ds_write_b16_d16_hi v39, v77 offset:128
    ds_write_b16 v39, v78 offset:96
    ds_write_b16_d16_hi v39, v78 offset:64
    ds_write_b16 v39, v79 offset:32
    ds_write_b16_d16_hi v39, v79 offset:0
L_fae_97:
L_fa_88:
    s_waitcnt lgkmcnt(0)
    s_barrier
    ds_read_b128 v[76:79], v36 offset:0
    ds_read_b128 v[80:83], v36 offset:64
    ds_read_b128 v[84:87], v36 offset:128
    ds_read_b128 v[88:91], v36 offset:192
    s_waitcnt lgkmcnt(3)
    v_mfma_f32_16x16x32_bf16 v[92:95], v[76:79], v[20:23], 0
    s_waitcnt lgkmcnt(2)
    v_mfma_f32_16x16x32_bf16 v[96:99], v[80:83], v[24:27], 0
    s_waitcnt lgkmcnt(1)
    v_mfma_f32_16x16x32_bf16 v[92:95], v[84:87], v[28:31], v[92:95]
    s_waitcnt lgkmcnt(0)
    v_mfma_f32_16x16x32_bf16 v[96:99], v[88:91], v[32:35], v[96:99]
    s_nop 7
    v_add_f32_e64 v92, v92, v96
    s_mov_b64 exec, 0xffff
    ds_write_b32 v37, v92
    s_mov_b64 exec, -1
    s_waitcnt lgkmcnt(0)
    s_barrier
    s_cmp_lg_u32 s40, 0
    s_cbranch_scc1 L_fb_98
    ds_read_b32 v80, v41 offset:52224
    ds_read_b32 v81, v41 offset:52288
    ds_read_b32 v82, v41 offset:52352
    ds_read_b32 v83, v41 offset:52416
    ds_read_b32 v84, v41 offset:52480
    ds_read_b32 v85, v41 offset:52544
    ds_read_b32 v86, v41 offset:52608
    ds_read_b32 v87, v41 offset:52672
    s_lshl_b32 s43, s54, 6
    s_add_u32 s43, s43, s78
    s_waitcnt lgkmcnt(0)
    v_add_f32 v80, v80, v81
    v_add_f32 v84, v84, v85
    v_add_f32 v82, v82, v83
    v_add_f32 v86, v86, v87
    v_add_f32 v80, v80, v82
    v_add_f32 v84, v84, v86
    v_mul_f32 v89, 0xbfb8aa3b, v80
    v_exp_f32 v89, v89
    s_nop 0
    v_add_f32 v89, 1.0, v89
    v_rcp_f32 v88, v89
    s_nop 0
    v_mul_f32 v80, v80, v88
    v_mul_f32_e64 v80, v80, v84
    s_nop 1
    v_mov_b32_dpp v90, v80 row_shl:1 row_mask:0xf bank_mask:0xf bound_ctrl:1
    v_cvt_pk_bf16_f32 v91, v80, v90
    s_mov_b32 exec_lo, 0x55555555
    s_mov_b32 exec_hi, 0
    buffer_store_dword v91, v42, s[12:15], s43 offen sc1
    s_mov_b64 exec, -1
L_fb_98:
    s_cmp_lg_u32 s83, 0
    s_cbranch_scc1 L_end
    s_mov_b32 s76, 1107968
    s_mov_b32 s77, 5050368
    s_mov_b32 s78, 1136640
    s_mov_b32 s79, 1182720
    s_mov_b32 s83, 1
    s_branch L_fa_loop
L_end:
    s_endpgm
L_codeend:
.section .rodata,"a"
.p2align 6
.amdhsa_kernel interleave_layers__spectral_fnet__moe_arch_mod__prompt_kernel
  .amdhsa_next_free_vgpr 128
  .amdhsa_next_free_sgpr 96
  .amdhsa_accum_offset 128
  .amdhsa_group_segment_fixed_size 0
  .amdhsa_kernarg_size 104
  .amdhsa_user_sgpr_count 2
  .amdhsa_user_sgpr_kernarg_segment_ptr 1
  .amdhsa_system_sgpr_workgroup_id_x 1
  .amdhsa_float_denorm_mode_32 3
.end_amdhsa_kernel
```
